```python
import torch

def _softmax(x, axis=-1):
    return torch.softmax(x, dim=axis)
def _gelu(x):
    return torch.nn.functional.gelu(x, approximate="tanh")
def _silu(x):
    return torch.nn.functional.silu(x)
def _sigmoid(x):
    return torch.sigmoid(x)
def _layernorm(x, axis=-1, eps=1e-5):
    m = x.mean(dim=axis, keepdim=True)
    v = x.var(dim=axis, keepdim=True, unbiased=False)
    return (x - m) / torch.sqrt(v + eps)
def _scatter_add(tgt, idx, src, axis=0):
    return tgt.clone().index_add_(axis, idx, src)
def _segment_sum(src, seg, n):
    out = torch.zeros((n,) + src.shape[1:], dtype=src.dtype)
    return out.index_add_(0, seg, src)
def _pad(x, pw):
    flat = tuple(v for pair in reversed(pw) for v in pair)
    return torch.nn.functional.pad(x, flat)

kernel_name = 'parallel_sum__linear_kernel_hedgehog__mixer_channel_mlp__prompt'

def setup_inputs():

    _w = (lambda a: (lambda t: t.to(torch.bfloat16) if t.is_floating_point() else t)(torch.as_tensor(a)))
    def _A_setup():
        B, S, D, H = 1, 2048, 640, 32
        Dh = D // H
        return {
            "x": _w((lambda *s: torch.randn(*s, dtype=torch.bfloat16) * 0.05)(B, S, D)),
            "wqkv": _w((lambda *s: torch.randn(*s, dtype=torch.bfloat16) * 0.2)(D, 3 * D)),
            "w_phi": _w((lambda *s: torch.randn(*s, dtype=torch.bfloat16) * 0.2)(H, Dh, Dh) * (Dh ** -0.5)),
            "wo": _w((lambda *s: torch.randn(*s, dtype=torch.bfloat16) * 0.05)(D, D)),
        }
    _A_in = _A_setup()

    def _B_setup():
        B, S, D, F = 1, 2048, 640, 1728
        return {
            "x": _w((lambda *s: torch.randn(*s, dtype=torch.bfloat16) * 0.05)(B, S, D)),
            "w1": _w((lambda *s: torch.randn(*s, dtype=torch.bfloat16) * 3.2)(D, F) * (D ** -0.5)),
            "b1": _w((lambda *s: torch.randn(*s, dtype=torch.bfloat16) * 1.6)(F)),
            "w2": _w((lambda *s: torch.randn(*s, dtype=torch.bfloat16) * 0.05)(F, D) * (F ** -0.5)),
            "b2": _w((lambda *s: torch.randn(*s, dtype=torch.bfloat16) * 0.05)(D)),
        }
    _B_in = _B_setup()

    return {
        "A_x": _A_in["x"],
        "A_wqkv": _A_in["wqkv"],
        "A_w_phi": _A_in["w_phi"],
        "A_wo": _A_in["wo"],
        "B_x": _B_in["x"],
        "B_w1": _B_in["w1"],
        "B_b1": _B_in["b1"],
        "B_w2": _B_in["w2"],
        "B_b2": _B_in["b2"],
    }

def reference(A_x, A_wqkv, A_w_phi, A_wo, B_x, B_w1, B_b1, B_w2, B_b2):
    def _A_ref(x, wqkv, w_phi, wo):
        B, S, D = x.shape
        H = 32; Dh = D // H
        qkv = (lambda x, *d: x.permute(*d))((x @ wqkv).reshape(B, S, 3, H, Dh), 2, 0, 3, 1, 4)
        q, k, v = qkv[0], qkv[1], qkv[2]
        pq = torch.einsum("bhsd,hdf->bhsf", q, w_phi)
        pk = torch.einsum("bhsd,hdf->bhsf", k, w_phi)
        phi_q = torch.concatenate([_softmax(pq, axis=-1), _softmax(-pq, axis=-1)], axis=-1)
        phi_k = torch.concatenate([_softmax(pk, axis=-1), _softmax(-pk, axis=-1)], axis=-1)
        kv = torch.einsum("bhsf,bhsd->bhfd", phi_k, v)
        z  = torch.einsum("bhsf->bhf", phi_k)
        num = torch.einsum("bhqf,bhfd->bhqd", phi_q, kv)
        den = torch.einsum("bhqf,bhf->bhq", phi_q, z)[..., None] + 1e-6
        o = num / den
        return (lambda x, *d: x.permute(*d))(o, 0, 2, 1, 3).reshape(B, S, D) @ wo

    def _B_ref(x, w1, b1, w2, b2):
        y = _layernorm(x, axis=-1)
        h = _gelu(torch.einsum("bsd,df->bsf", y, w1) + b1)
        return torch.einsum("bsf,fd->bsd", h, w2) + b2

    x = A_x
    xn = _layernorm(x, axis=-1)
    return x + _A_ref(xn, A_wqkv, A_w_phi, A_wo) + _B_ref(xn, B_w1, B_b1, B_w2, B_b2)
```

```asm
; @launch kernel=k1_kernel grid=(256,1,1) block=(512,1,1) lds=163840
; @launch kernel=k2_kernel grid=(496,1,1) block=(512,1,1) lds=81920
.amdgcn_target "amdgcn-amd-amdhsa--gfx950"
.text
    .p2align 8
    .type k1_kernel,@function
k1_kernel:
    s_load_dwordx4 s[4:7], s[0:1], 0
    s_load_dwordx4 s[12:15], s[0:1], 40
    s_load_dwordx2 s[10:11], s[0:1], 88
    s_load_dwordx2 s[8:9], s[0:1], 16
    s_load_dwordx2 s[80:81], s[0:1], 80
    v_lshrrev_b32 v2, 6, v0
    v_and_b32 v1, 63, v0
    s_and_b32 s36, s2, 7
    v_readfirstlane_b32 s40, v2
    s_cmp_ge_u32 s2, 256
    s_cbranch_scc0 k1_kernel_in
    s_endpgm
k1_kernel_in:
    s_mov_b32 s82, s2
    s_cmp_lt_u32 s40, 4
    s_cbranch_scc0 k1_kernel_notask
    s_setprio 3
    s_lshl_b32 s62, s40, 6
    v_add_u32 v144, s62, v1
    v_and_b32 v145, 15, v144
    v_lshrrev_b32 v144, 4, v144
    s_mul_i32 s62, s82, 9
    v_add_u32 v146, s62, v144
    v_mul_u32_u24 v147, 1280, v146
    v_lshl_add_u32 v147, v145, 4, v147
    v_mov_b32 v148, 2146435072
    v_cmp_gt_u32 vcc, 9, v144
    s_lshr_b32 s63, s82, 2
    s_and_b32 s64, s82, 3
    v_cndmask_b32 v147, v148, v147, vcc
    s_waitcnt lgkmcnt(0)
    s_mov_b32 s16, s4
    s_mov_b32 s17, s5
    s_mov_b32 s18, 2621440
    s_mov_b32 s19, 0x20000
    s_mov_b32 s24, s10
    s_mov_b32 s25, s11
    s_mov_b32 s26, 33554432
    s_mov_b32 s27, 0x20000
    s_cmp_ge_u32 s63, 30
    s_cselect_b32 s84, s12, s6
    s_cselect_b32 s85, s13, s7
    s_mov_b32 s86, 2457600
    s_cselect_b32 s86, 2211840, s86
    s_mov_b32 s65, 3840
    s_cselect_b32 s65, 3456, s65
    s_cselect_b32 s66, 30, 0
    s_mov_b32 s87, 0x20000
    s_sub_u32 s66, s63, s66
    buffer_load_dwordx4 v[156:159], v147, s[16:19], 0 offen offset:0
    buffer_load_dwordx4 v[160:163], v147, s[16:19], 0 offen offset:256
    buffer_load_dwordx4 v[164:167], v147, s[16:19], 0 offen offset:512
    buffer_load_dwordx4 v[168:171], v147, s[16:19], 0 offen offset:768
    buffer_load_dwordx4 v[172:175], v147, s[16:19], 0 offen offset:1024
    v_lshrrev_b32 v149, 3, v1
    v_and_b32 v150, 7, v1
    s_mul_i32 s67, s64, 160
    s_mul_i32 s68, s40, 40
    s_add_u32 s67, s67, s68
    v_add_u32 v149, s67, v149
    v_mul_lo_u32 v149, v149, s65
    s_lshl_b32 s67, s66, 7
    v_lshl_add_u32 v150, v150, 4, s67
    v_add_u32 v149, v149, v150
    s_cmp_lt_u32 s82, 228
    s_cselect_b32 s67, 0, 2146435072
    v_add_u32 v149, s67, v149
    s_lshl_b32 s68, s65, 3
    s_mov_b32 s69, 0
    buffer_load_dwordx4 v[176:179], v149, s[84:87], s69 offen
    s_add_u32 s69, s69, s68
    buffer_load_dwordx4 v[180:183], v149, s[84:87], s69 offen
    s_add_u32 s69, s69, s68
    buffer_load_dwordx4 v[184:187], v149, s[84:87], s69 offen
    s_add_u32 s69, s69, s68
    buffer_load_dwordx4 v[188:191], v149, s[84:87], s69 offen
    s_add_u32 s69, s69, s68
    buffer_load_dwordx4 v[192:195], v149, s[84:87], s69 offen
    s_setprio 0
k1_kernel_notask:
    s_lshr_b32 s37, s2, 3
    s_and_b32 s38, s36, 1
    s_lshr_b32 s39, s36, 1
    s_mul_i32 s41, s37, 37
    s_lshr_b32 s41, s41, 8
    s_mul_i32 s43, s41, 7
    s_sub_u32 s43, s37, s43
    s_add_u32 s43, s43, 8
    s_lshr_b32 s46, s37, 3
    s_and_b32 s47, s37, 7
    s_cmp_eq_u32 s38, 0
    s_cselect_b32 s41, s46, s41
    s_cselect_b32 s43, s47, s43
    s_cselect_b32 s46, 0, s37
    s_cmp_ge_u32 s46, 28
    s_cbranch_scc1 k1_kernel_idle
    s_lshl_b32 s42, s39, 2
    s_add_u32 s42, s42, s41
    s_lshr_b32 s46, s43, 2
    s_and_b32 s44, s46, 1
    s_lshr_b32 s46, s46, 1
    s_lshl_b32 s46, s46, 2
    s_and_b32 s45, s43, 3
    s_add_u32 s45, s45, s46
    s_lshl_b32 s48, s42, 7
    s_cmp_lt_u32 s40, 4
    s_cbranch_scc1 k1_kernel_cons
    s_sub_u32 s50, s40, 4
    v_lshrrev_b32 v2, 3, v1
    v_and_b32 v3, 7, v1
    v_lshrrev_b32 v4, 4, v1
    v_xor_b32 v3, v3, v4
    s_lshl_b32 s51, s50, 5
    s_add_u32 s51, s51, s48
    v_add_u32 v2, s51, v2
    v_mul_u32_u24 v2, 1280, v2
    v_lshl_add_u32 v24, v3, 4, v2
    v_add_u32 v25, 9216, v24
    v_add_u32 v26, 18432, v24
    v_add_u32 v27, 27648, v24
    v_xor_b32 v25, 64, v25
    v_xor_b32 v27, 64, v27
    s_lshl_b32 s57, s50, 12
    s_add_u32 s57, s57, 98304
    s_mov_b32 s55, 0
    s_mov_b32 s58, 0
    s_waitcnt lgkmcnt(0)
    s_mov_b32 s16, s4
    s_mov_b32 s17, s5
    s_mov_b32 s18, 2621440
    s_mov_b32 s19, 0x20000
    s_mov_b32 m0, s57
    s_add_u32 s58, s58, 1
    buffer_load_dwordx4 v24, s[16:19], s55 offen lds
    buffer_load_dwordx4 v25, s[16:19], s55 offen offset:1024 lds
    buffer_load_dwordx4 v26, s[16:19], s55 offen offset:2048 lds
    buffer_load_dwordx4 v27, s[16:19], s55 offen offset:3072 lds
    s_add_u32 s55, s55, 128
    s_cmp_eq_u32 s58, 3
    s_cselect_b32 s61, 49152, 0
    s_cselect_b32 s58, 0, s58
    s_add_u32 s57, s57, 16384
    s_sub_u32 s57, s57, s61
    s_cmp_eq_u32 s44, 0
    s_mov_b32 s47, 3840
    s_cselect_b32 s47, s47, 3456
    s_cselect_b32 s20, s6, s12
    s_cselect_b32 s21, s7, s13
    s_mov_b32 s22, 2457600
    s_cselect_b32 s22, s22, 2211840
    s_mov_b32 s23, 0x20000
    v_lshrrev_b32 v2, 5, v1
    v_and_b32 v3, 31, v1
    v_lshlrev_b32 v4, 1, v2
    v_xor_b32 v3, v3, v4
    s_lshl_b32 s51, s50, 4
    v_add_u32 v5, s51, v2
    v_mul_lo_u32 v5, v5, s47
    v_mov_b32 v15, 2146435072
    s_cmp_eq_u32 s44, 0
    s_cbranch_scc0 k1_kernel_vw
    s_mul_i32 s51, s45, 160
    v_xor_b32 v10, 0, v3
    v_mul_u32_u24 v11, 26, v10
    v_lshrrev_b32 v11, 8, v11
    v_mul_u32_u24 v12, 1120, v11
    v_lshl_add_u32 v12, v10, 4, v12
    v_cmp_gt_u32 vcc, 3, v11
    v_add_u32 v12, s51, v12
    s_nop 0
    v_cndmask_b32 v6, v15, v12, vcc
    v_xor_b32 v10, 4, v3
    v_mul_u32_u24 v11, 26, v10
    v_lshrrev_b32 v11, 8, v11
    v_mul_u32_u24 v12, 1120, v11
    v_lshl_add_u32 v12, v10, 4, v12
    v_cmp_gt_u32 vcc, 3, v11
    v_add_u32 v12, s51, v12
    s_nop 0
    v_cndmask_b32 v7, v15, v12, vcc
    v_xor_b32 v10, 8, v3
    v_mul_u32_u24 v11, 26, v10
    v_lshrrev_b32 v11, 8, v11
    v_mul_u32_u24 v12, 1120, v11
    v_lshl_add_u32 v12, v10, 4, v12
    v_cmp_gt_u32 vcc, 3, v11
    v_add_u32 v12, s51, v12
    s_nop 0
    v_cndmask_b32 v8, v15, v12, vcc
    v_xor_b32 v10, 12, v3
    v_mul_u32_u24 v11, 26, v10
    v_lshrrev_b32 v11, 8, v11
    v_mul_u32_u24 v12, 1120, v11
    v_lshl_add_u32 v12, v10, 4, v12
    v_cmp_gt_u32 vcc, 3, v11
    v_add_u32 v12, s51, v12
    s_nop 0
    v_cndmask_b32 v9, v15, v12, vcc
    s_branch k1_kernel_vd
k1_kernel_vw:
    s_lshl_b32 s51, s45, 2
    s_lshl_b32 s52, s45, 9
    v_xor_b32 v10, 0, v3
    v_lshrrev_b32 v11, 3, v10
    v_add_u32 v11, s51, v11
    v_lshlrev_b32 v12, 4, v10
    v_cmp_gt_u32 vcc, 27, v11
    v_add_u32 v12, s52, v12
    s_nop 0
    v_cndmask_b32 v6, v15, v12, vcc
    v_xor_b32 v10, 4, v3
    v_lshrrev_b32 v11, 3, v10
    v_add_u32 v11, s51, v11
    v_lshlrev_b32 v12, 4, v10
    v_cmp_gt_u32 vcc, 27, v11
    v_add_u32 v12, s52, v12
    s_nop 0
    v_cndmask_b32 v7, v15, v12, vcc
    v_xor_b32 v10, 8, v3
    v_lshrrev_b32 v11, 3, v10
    v_add_u32 v11, s51, v11
    v_lshlrev_b32 v12, 4, v10
    v_cmp_gt_u32 vcc, 27, v11
    v_add_u32 v12, s52, v12
    s_nop 0
    v_cndmask_b32 v8, v15, v12, vcc
    v_xor_b32 v10, 12, v3
    v_lshrrev_b32 v11, 3, v10
    v_add_u32 v11, s51, v11
    v_lshlrev_b32 v12, 4, v10
    v_cmp_gt_u32 vcc, 27, v11
    v_add_u32 v12, s52, v12
    s_nop 0
    v_cndmask_b32 v9, v15, v12, vcc
k1_kernel_vd:
    s_mul_i32 s51, s47, 0
    v_add3_u32 v16, v5, v6, s51
    s_mul_i32 s51, s47, 2
    s_sub_u32 s51, s51, 1024
    v_add3_u32 v17, v5, v7, s51
    s_mul_i32 s51, s47, 4
    s_sub_u32 s51, s51, 2048
    v_add3_u32 v18, v5, v6, s51
    s_mul_i32 s51, s47, 6
    s_sub_u32 s51, s51, 3072
    v_add3_u32 v19, v5, v7, s51
    s_mul_i32 s51, s47, 8
    v_add3_u32 v20, v5, v8, s51
    s_mul_i32 s51, s47, 10
    s_sub_u32 s51, s51, 1024
    v_add3_u32 v21, v5, v9, s51
    s_mul_i32 s51, s47, 12
    s_sub_u32 s51, s51, 2048
    v_add3_u32 v22, v5, v8, s51
    s_mul_i32 s51, s47, 14
    s_sub_u32 s51, s51, 3072
    v_add3_u32 v23, v5, v9, s51
    s_mov_b32 s54, 0
    s_lshl_b32 s56, s50, 13
    s_mov_b32 s53, 0
    s_mov_b32 s93, 0
    s_add_u32 s83, s56, 4096
    s_mov_b32 s49, 0
    s_lshl_b32 s60, s47, 6
    s_mov_b32 m0, s56
    s_add_u32 s53, s53, 1
    buffer_load_dwordx4 v16, s[20:23], s54 offen lds
    buffer_load_dwordx4 v17, s[20:23], s54 offen offset:1024 lds
    buffer_load_dwordx4 v18, s[20:23], s54 offen offset:2048 lds
    buffer_load_dwordx4 v19, s[20:23], s54 offen offset:3072 lds
    s_add_u32 s54, s54, s60
    s_cmp_eq_u32 s53, 3
    s_cselect_b32 s59, 98304, 0
    s_cselect_b32 s53, 0, s53
    s_add_u32 s56, s56, 32768
    s_sub_u32 s56, s56, s59
    s_mov_b32 m0, s83
    s_add_u32 s49, s49, 1
    buffer_load_dwordx4 v20, s[20:23], s93 offen lds
    buffer_load_dwordx4 v21, s[20:23], s93 offen offset:1024 lds
    buffer_load_dwordx4 v22, s[20:23], s93 offen offset:2048 lds
    buffer_load_dwordx4 v23, s[20:23], s93 offen offset:3072 lds
    s_add_u32 s93, s93, s60
    s_cmp_eq_u32 s49, 3
    s_cselect_b32 s59, 98304, 0
    s_cselect_b32 s49, 0, s49
    s_add_u32 s83, s83, 32768
    s_sub_u32 s83, s83, s59
    s_mov_b32 m0, s57
    s_add_u32 s58, s58, 1
    buffer_load_dwordx4 v24, s[16:19], s55 offen lds
    buffer_load_dwordx4 v25, s[16:19], s55 offen offset:1024 lds
    buffer_load_dwordx4 v26, s[16:19], s55 offen offset:2048 lds
    buffer_load_dwordx4 v27, s[16:19], s55 offen offset:3072 lds
    s_add_u32 s55, s55, 128
    s_cmp_eq_u32 s58, 3
    s_cselect_b32 s61, 49152, 0
    s_cselect_b32 s58, 0, s58
    s_add_u32 s57, s57, 16384
    s_sub_u32 s57, s57, s61
    s_mov_b32 m0, s56
    s_add_u32 s53, s53, 1
    buffer_load_dwordx4 v16, s[20:23], s54 offen lds
    buffer_load_dwordx4 v17, s[20:23], s54 offen offset:1024 lds
    buffer_load_dwordx4 v18, s[20:23], s54 offen offset:2048 lds
    buffer_load_dwordx4 v19, s[20:23], s54 offen offset:3072 lds
    s_add_u32 s54, s54, s60
    s_cmp_eq_u32 s53, 3
    s_cselect_b32 s59, 98304, 0
    s_cselect_b32 s53, 0, s53
    s_add_u32 s56, s56, 32768
    s_sub_u32 s56, s56, s59
    s_mov_b32 s24, s10
    s_mov_b32 s25, s11
    s_mov_b32 s26, 33554432
    s_mov_b32 s27, 0x20000
    s_mov_b32 s28, s8
    s_mov_b32 s29, s9
    s_mov_b32 s30, 25600
    s_mov_b32 s31, 0x20000
    s_mov_b32 s32, s14
    s_mov_b32 s33, s15
    s_mov_b32 s34, 3456
    s_mov_b32 s35, 0x20000
    s_cmp_eq_u32 s50, 0
    s_cbranch_scc0 k1_kernel_noz
    v_lshlrev_b32 v2, 4, v1
    v_mov_b32 v8, 0
    v_mov_b32 v9, 0
    v_mov_b32 v10, 0
    v_mov_b32 v11, 0
    v_add_u32 v3, 159744, v2
    ds_write_b128 v3, v[8:11]
k1_kernel_noz:
    s_lshl_b32 s51, s50, 6
    v_add_u32 v2, s51, v1
    s_cmp_eq_u32 s44, 0
    s_cbranch_scc0 k1_kernel_cw
    v_mul_u32_u24 v3, 205, v2
    v_lshrrev_b32 v3, 14, v3
    v_mul_u32_u24 v4, 560, v3
    v_add_u32 v4, v4, v2
    s_mul_i32 s51, s45, 80
    v_add_u32 v4, s51, v4
    v_cmp_gt_u32 vcc, 240, v2
    v_lshlrev_b32 v4, 2, v4
    v_add_u32 v4, 29884416, v4
    v_cndmask_b32 v4, v15, v4, vcc
    v_mov_b32 v5, v15
    s_branch k1_kernel_cd
k1_kernel_cw:
    s_lshl_b32 s51, s45, 8
    v_add_u32 v4, s51, v2
    v_lshlrev_b32 v5, 1, v4
    v_cmp_gt_u32 vcc, 1728, v4
    v_add_u32 v4, 1920, v4
    v_lshlrev_b32 v4, 2, v4
    v_add_u32 v4, 29884416, v4
    v_cndmask_b32 v4, v15, v4, vcc
k1_kernel_cd:
    s_lshl_b32 s51, s50, 6
    s_add_u32 s51, s51, s48
    v_add_u32 v6, s51, v1
    v_lshlrev_b32 v6, 4, v6
    v_add_u32 v6, 29360128, v6
    s_cmp_lt_u32 s50, 2
    s_cselect_b64 vcc, -1, 0
    s_nop 1
    v_cndmask_b32 v6, v15, v6, vcc
    s_waitcnt lgkmcnt(0)
    s_waitcnt vmcnt(8)
    s_barrier
    s_setprio 3
    s_mov_b32 m0, s83
    s_add_u32 s49, s49, 1
    buffer_load_dwordx4 v20, s[20:23], s93 offen lds
    buffer_load_dwordx4 v21, s[20:23], s93 offen offset:1024 lds
    buffer_load_dwordx4 v22, s[20:23], s93 offen offset:2048 lds
    buffer_load_dwordx4 v23, s[20:23], s93 offen offset:3072 lds
    s_add_u32 s93, s93, s60
    s_cmp_eq_u32 s49, 3
    s_cselect_b32 s59, 98304, 0
    s_cselect_b32 s49, 0, s49
    s_add_u32 s83, s83, 32768
    s_sub_u32 s83, s83, s59
    s_mov_b32 m0, s57
    s_add_u32 s58, s58, 1
    buffer_load_dwordx4 v24, s[16:19], s55 offen lds
    buffer_load_dwordx4 v25, s[16:19], s55 offen offset:1024 lds
    buffer_load_dwordx4 v26, s[16:19], s55 offen offset:2048 lds
    buffer_load_dwordx4 v27, s[16:19], s55 offen offset:3072 lds
    s_add_u32 s55, s55, 128
    s_cmp_eq_u32 s58, 3
    s_cselect_b32 s61, 49152, 0
    s_cselect_b32 s58, 0, s58
    s_add_u32 s57, s57, 16384
    s_sub_u32 s57, s57, s61
    s_mov_b32 m0, s56
    s_add_u32 s53, s53, 1
    buffer_load_dwordx4 v16, s[20:23], s54 offen lds
    buffer_load_dwordx4 v17, s[20:23], s54 offen offset:1024 lds
    buffer_load_dwordx4 v18, s[20:23], s54 offen offset:2048 lds
    buffer_load_dwordx4 v19, s[20:23], s54 offen offset:3072 lds
    s_add_u32 s54, s54, s60
    s_cmp_eq_u32 s53, 3
    s_cselect_b32 s59, 98304, 0
    s_cselect_b32 s53, 0, s53
    s_add_u32 s56, s56, 32768
    s_sub_u32 s56, s56, s59
    s_waitcnt vmcnt(8)
    s_barrier
    s_mov_b32 m0, s83
    s_add_u32 s49, s49, 1
    buffer_load_dwordx4 v20, s[20:23], s93 offen lds
    buffer_load_dwordx4 v21, s[20:23], s93 offen offset:1024 lds
    buffer_load_dwordx4 v22, s[20:23], s93 offen offset:2048 lds
    buffer_load_dwordx4 v23, s[20:23], s93 offen offset:3072 lds
    s_add_u32 s93, s93, s60
    s_cmp_eq_u32 s49, 3
    s_cselect_b32 s59, 98304, 0
    s_cselect_b32 s49, 0, s49
    s_add_u32 s83, s83, 32768
    s_sub_u32 s83, s83, s59
    s_mov_b32 m0, s57
    s_add_u32 s58, s58, 1
    buffer_load_dwordx4 v24, s[16:19], s55 offen lds
    buffer_load_dwordx4 v25, s[16:19], s55 offen offset:1024 lds
    buffer_load_dwordx4 v26, s[16:19], s55 offen offset:2048 lds
    buffer_load_dwordx4 v27, s[16:19], s55 offen offset:3072 lds
    s_add_u32 s55, s55, 128
    s_cmp_eq_u32 s58, 3
    s_cselect_b32 s61, 49152, 0
    s_cselect_b32 s58, 0, s58
    s_add_u32 s57, s57, 16384
    s_sub_u32 s57, s57, s61
    s_mov_b32 m0, s56
    s_add_u32 s53, s53, 1
    buffer_load_dwordx4 v16, s[20:23], s54 offen lds
    buffer_load_dwordx4 v17, s[20:23], s54 offen offset:1024 lds
    buffer_load_dwordx4 v18, s[20:23], s54 offen offset:2048 lds
    buffer_load_dwordx4 v19, s[20:23], s54 offen offset:3072 lds
    s_add_u32 s54, s54, s60
    s_cmp_eq_u32 s53, 3
    s_cselect_b32 s59, 98304, 0
    s_cselect_b32 s53, 0, s53
    s_add_u32 s56, s56, 32768
    s_sub_u32 s56, s56, s59
    s_waitcnt vmcnt(8)
    s_barrier
    s_mov_b32 m0, s83
    s_add_u32 s49, s49, 1
    buffer_load_dwordx4 v20, s[20:23], s93 offen lds
    buffer_load_dwordx4 v21, s[20:23], s93 offen offset:1024 lds
    buffer_load_dwordx4 v22, s[20:23], s93 offen offset:2048 lds
    buffer_load_dwordx4 v23, s[20:23], s93 offen offset:3072 lds
    s_add_u32 s93, s93, s60
    s_cmp_eq_u32 s49, 3
    s_cselect_b32 s59, 98304, 0
    s_cselect_b32 s49, 0, s49
    s_add_u32 s83, s83, 32768
    s_sub_u32 s83, s83, s59
    s_mov_b32 m0, s57
    s_add_u32 s58, s58, 1
    buffer_load_dwordx4 v24, s[16:19], s55 offen lds
    buffer_load_dwordx4 v25, s[16:19], s55 offen offset:1024 lds
    buffer_load_dwordx4 v26, s[16:19], s55 offen offset:2048 lds
    buffer_load_dwordx4 v27, s[16:19], s55 offen offset:3072 lds
    s_add_u32 s55, s55, 128
    s_cmp_eq_u32 s58, 3
    s_cselect_b32 s61, 49152, 0
    s_cselect_b32 s58, 0, s58
    s_add_u32 s57, s57, 16384
    s_sub_u32 s57, s57, s61
    s_mov_b32 m0, s56
    s_add_u32 s53, s53, 1
    buffer_load_dwordx4 v16, s[20:23], s54 offen lds
    buffer_load_dwordx4 v17, s[20:23], s54 offen offset:1024 lds
    buffer_load_dwordx4 v18, s[20:23], s54 offen offset:2048 lds
    buffer_load_dwordx4 v19, s[20:23], s54 offen offset:3072 lds
    s_add_u32 s54, s54, s60
    s_cmp_eq_u32 s53, 3
    s_cselect_b32 s59, 98304, 0
    s_cselect_b32 s53, 0, s53
    s_add_u32 s56, s56, 32768
    s_sub_u32 s56, s56, s59
    s_mov_b32 s72, s80
    s_mov_b32 s73, s81
    s_mov_b32 s74, 256
    s_mov_b32 s75, 0x20000
    s_and_b32 s67, s2, 1
    s_lshl_b32 s67, s67, 7
    s_cmp_eq_u32 s50, 0
    s_cselect_b32 s67, s67, 2146435072
    s_cmp_lt_u32 s2, 228
    s_cselect_b32 s67, s67, 2146435072
    v_mov_b32 v64, s67
    v_mov_b32 v65, 1
    s_mov_b64 exec, 1
    buffer_atomic_add v65, v64, s[72:75], 0 offen sc1
    s_mov_b64 exec, -1
    s_waitcnt vmcnt(8)
    s_barrier
    s_mov_b32 m0, s83
    s_add_u32 s49, s49, 1
    buffer_load_dwordx4 v20, s[20:23], s93 offen lds
    buffer_load_dwordx4 v21, s[20:23], s93 offen offset:1024 lds
    buffer_load_dwordx4 v22, s[20:23], s93 offen offset:2048 lds
    buffer_load_dwordx4 v23, s[20:23], s93 offen offset:3072 lds
    s_add_u32 s93, s93, s60
    s_cmp_eq_u32 s49, 3
    s_cselect_b32 s59, 98304, 0
    s_cselect_b32 s49, 0, s49
    s_add_u32 s83, s83, 32768
    s_sub_u32 s83, s83, s59
    s_mov_b32 m0, s57
    s_add_u32 s58, s58, 1
    buffer_load_dwordx4 v24, s[16:19], s55 offen lds
    buffer_load_dwordx4 v25, s[16:19], s55 offen offset:1024 lds
    buffer_load_dwordx4 v26, s[16:19], s55 offen offset:2048 lds
    buffer_load_dwordx4 v27, s[16:19], s55 offen offset:3072 lds
    s_add_u32 s55, s55, 128
    s_cmp_eq_u32 s58, 3
    s_cselect_b32 s61, 49152, 0
    s_cselect_b32 s58, 0, s58
    s_add_u32 s57, s57, 16384
    s_sub_u32 s57, s57, s61
    s_mov_b32 m0, s56
    s_add_u32 s53, s53, 1
    buffer_load_dwordx4 v16, s[20:23], s54 offen lds
    buffer_load_dwordx4 v17, s[20:23], s54 offen offset:1024 lds
    buffer_load_dwordx4 v18, s[20:23], s54 offen offset:2048 lds
    buffer_load_dwordx4 v19, s[20:23], s54 offen offset:3072 lds
    s_add_u32 s54, s54, s60
    s_cmp_eq_u32 s53, 3
    s_cselect_b32 s59, 98304, 0
    s_cselect_b32 s53, 0, s53
    s_add_u32 s56, s56, 32768
    s_sub_u32 s56, s56, s59
    s_mov_b32 s62, 4
k1_kernel_ploop:
    s_waitcnt vmcnt(8)
    s_barrier
    s_mov_b32 m0, s83
    s_add_u32 s49, s49, 1
    buffer_load_dwordx4 v20, s[20:23], s93 offen lds
    buffer_load_dwordx4 v21, s[20:23], s93 offen offset:1024 lds
    buffer_load_dwordx4 v22, s[20:23], s93 offen offset:2048 lds
    buffer_load_dwordx4 v23, s[20:23], s93 offen offset:3072 lds
    s_add_u32 s93, s93, s60
    s_cmp_eq_u32 s49, 3
    s_cselect_b32 s59, 98304, 0
    s_cselect_b32 s49, 0, s49
    s_add_u32 s83, s83, 32768
    s_sub_u32 s83, s83, s59
    s_mov_b32 m0, s57
    s_add_u32 s58, s58, 1
    buffer_load_dwordx4 v24, s[16:19], s55 offen lds
    buffer_load_dwordx4 v25, s[16:19], s55 offen offset:1024 lds
    buffer_load_dwordx4 v26, s[16:19], s55 offen offset:2048 lds
    buffer_load_dwordx4 v27, s[16:19], s55 offen offset:3072 lds
    s_add_u32 s55, s55, 128
    s_cmp_eq_u32 s58, 3
    s_cselect_b32 s61, 49152, 0
    s_cselect_b32 s58, 0, s58
    s_add_u32 s57, s57, 16384
    s_sub_u32 s57, s57, s61
    s_mov_b32 m0, s56
    s_add_u32 s53, s53, 1
    buffer_load_dwordx4 v16, s[20:23], s54 offen lds
    buffer_load_dwordx4 v17, s[20:23], s54 offen offset:1024 lds
    buffer_load_dwordx4 v18, s[20:23], s54 offen offset:2048 lds
    buffer_load_dwordx4 v19, s[20:23], s54 offen offset:3072 lds
    s_add_u32 s54, s54, s60
    s_cmp_eq_u32 s53, 3
    s_cselect_b32 s59, 98304, 0
    s_cselect_b32 s53, 0, s53
    s_add_u32 s56, s56, 32768
    s_sub_u32 s56, s56, s59
    s_sub_u32 s62, s62, 1
    s_cmp_lg_u32 s62, 0
    s_cbranch_scc1 k1_kernel_ploop
    s_waitcnt vmcnt(8)
    s_barrier
    s_mov_b32 m0, s83
    s_add_u32 s49, s49, 1
    buffer_load_dwordx4 v20, s[20:23], s93 offen lds
    buffer_load_dwordx4 v21, s[20:23], s93 offen offset:1024 lds
    buffer_load_dwordx4 v22, s[20:23], s93 offen offset:2048 lds
    buffer_load_dwordx4 v23, s[20:23], s93 offen offset:3072 lds
    s_add_u32 s93, s93, s60
    s_cmp_eq_u32 s49, 3
    s_cselect_b32 s59, 98304, 0
    s_cselect_b32 s49, 0, s49
    s_add_u32 s83, s83, 32768
    s_sub_u32 s83, s83, s59
    s_mov_b32 s51, 0
    buffer_load_dword v44, v4, s[24:27], s51 offen sc1
    s_add_u32 s51, s51, 14848
    buffer_load_dword v45, v4, s[24:27], s51 offen sc1
    s_add_u32 s51, s51, 14848
    buffer_load_dword v46, v4, s[24:27], s51 offen sc1
    s_add_u32 s51, s51, 14848
    buffer_load_dword v47, v4, s[24:27], s51 offen sc1
    s_add_u32 s51, s51, 14848
    buffer_load_dword v48, v4, s[24:27], s51 offen sc1
    s_add_u32 s51, s51, 14848
    buffer_load_dword v49, v4, s[24:27], s51 offen sc1
    s_add_u32 s51, s51, 14848
    buffer_load_dword v50, v4, s[24:27], s51 offen sc1
    s_add_u32 s51, s51, 14848
    buffer_load_dword v51, v4, s[24:27], s51 offen sc1
    s_add_u32 s51, s51, 14848
    buffer_load_dword v52, v4, s[24:27], s51 offen sc1
    s_add_u32 s51, s51, 14848
    buffer_load_dword v53, v4, s[24:27], s51 offen sc1
    s_add_u32 s51, s51, 14848
    buffer_load_dword v54, v4, s[24:27], s51 offen sc1
    s_add_u32 s51, s51, 14848
    buffer_load_dword v55, v4, s[24:27], s51 offen sc1
    s_add_u32 s51, s51, 14848
    buffer_load_dword v56, v4, s[24:27], s51 offen sc1
    s_add_u32 s51, s51, 14848
    buffer_load_dword v57, v4, s[24:27], s51 offen sc1
    s_add_u32 s51, s51, 14848
    buffer_load_dword v58, v4, s[24:27], s51 offen sc1
    s_add_u32 s51, s51, 14848
    buffer_load_dword v59, v4, s[24:27], s51 offen sc1
    buffer_load_dwordx4 v[36:39], v6, s[24:27], 0 offen sc1
    buffer_load_ushort v32, v5, s[32:35], 0 offen
    s_cmp_eq_u32 s50, 3
    s_cselect_b32 s51, 1, 0
    s_cmp_eq_u32 s44, 0
    s_cselect_b32 s51, s51, 0
    s_cmp_eq_u32 s51, 1
    s_cbranch_scc0 k1_kernel_nophi
    v_lshlrev_b32 v7, 4, v1
    s_mul_i32 s51, s45, 3200
    s_mov_b32 m0, 155648
    s_nop 0
    buffer_load_dwordx4 v7, s[28:31], s51 offen lds
    buffer_load_dwordx4 v7, s[28:31], s51 offen offset:1024 lds
    buffer_load_dwordx4 v7, s[28:31], s51 offen offset:2048 lds
    buffer_load_dwordx4 v7, s[28:31], s51 offen offset:3072 lds
k1_kernel_nophi:
    s_waitcnt vmcnt(0)
    s_barrier
    v_add_f32 v44, v44, v45
    v_add_f32 v44, v44, v46
    v_add_f32 v44, v44, v47
    v_add_f32 v44, v44, v48
    v_add_f32 v44, v44, v49
    v_add_f32 v44, v44, v50
    v_add_f32 v44, v44, v51
    v_add_f32 v44, v44, v52
    v_add_f32 v44, v44, v53
    v_add_f32 v44, v44, v54
    v_add_f32 v44, v44, v55
    v_add_f32 v44, v44, v56
    v_add_f32 v44, v44, v57
    v_add_f32 v44, v44, v58
    v_add_f32 v44, v44, v59
    v_and_b32 v29, 0xffff0000, v44
    v_sub_f32 v30, v44, v29
    v_cvt_pk_bf16_f32 v28, v29, v29
    v_cvt_pk_bf16_f32 v29, v30, v30
    v_lshl_or_b32 v30, v32, 16, v32
    v_mov_b32 v31, 0
    v_lshlrev_b32 v2, 4, v2
    v_add_u32 v2, 151552, v2
    ds_write_b128 v2, v[28:31]
    s_cmp_lt_u32 s50, 2
    s_cbranch_scc0 k1_kernel_notok2
    s_lshl_b32 s51, s50, 6
    v_add_u32 v6, s51, v1
    v_mov_b32 v40, v36
    v_mov_b32 v41, v36
    v_mov_b32 v42, v37
    v_mov_b32 v43, 0
    v_lshlrev_b32 v7, 4, v6
    v_add_u32 v8, 147456, v7
    ds_write_b128 v8, v[40:43]
    s_mov_b32 s51, 0xc0135761
    s_mov_b32 s52, 0xbdd2d3e8
    v_mov_b32 v60, v38
    v_rcp_f32 v61, v39
    v_mul_f32 v62, s51, v39
    v_mul_f32 v63, v39, v39
    v_mul_f32 v63, v63, v39
    v_mul_f32 v63, s52, v63
    v_add_u32 v8, 149504, v7
    ds_write_b128 v8, v[60:63]
k1_kernel_notok2:
    s_waitcnt lgkmcnt(0)
    s_barrier
    s_cmp_eq_u32 s44, 0
    s_cbranch_scc1 k1_kernel_pq
    s_and_b32 s68, s42, 3
    s_and_b32 s69, s45, 3
    s_or_b32 s68, s68, s50
    s_cmp_eq_u32 s68, 0
    s_cbranch_scc0 k1_kernel_ncp
    s_cmp_lt_u32 s69, 2
    s_cbranch_scc0 k1_kernel_ncp
    s_getpc_b64 s[66:67]
k1_kernel_pce:
    s_add_u32 s66, s66, k2_kernel-k1_kernel_pce
    s_addc_u32 s67, s67, 0
    s_lshl_b32 s70, s69, 6
    v_add_u32 v246, s70, v1
    v_lshlrev_b32 v246, 7, v246
    s_mov_b32 s70, code_end-k2_kernel-4
    v_min_u32 v246, s70, v246
    v_mov_b32 v247, s67
    v_add_co_u32 v246, vcc, s66, v246
    v_addc_co_u32 v247, vcc, 0, v247, vcc
    global_load_dword v248, v[246:247], off
k1_kernel_ncp:
    s_setprio 0
    v_and_b32 v8, 15, v1
    v_lshrrev_b32 v9, 4, v1
    s_lshr_b32 s63, s50, 1
    s_and_b32 s64, s50, 1
    s_lshl_b32 s65, s63, 6
    s_mul_i32 s53, s50, 17408
    s_add_u32 s53, s53, 65536
    v_mul_u32_u24 v10, 272, v8
    v_lshl_add_u32 v10, v9, 3, v10
    v_add_u32 v10, s53, v10
    v_lshrrev_b32 v11, 4, v1
    v_mul_u32_u24 v11, 272, v11
    v_lshl_add_u32 v11, v8, 4, v11
    v_add_u32 v11, s53, v11
    s_add_u32 s53, s48, s65
    v_add_u32 v12, s53, v9
    s_movk_i32 s54, 4736
    v_mul_lo_u32 v12, v12, s54
    s_lshl_b32 s54, s45, 9
    s_lshl_b32 s55, s64, 8
    s_add_u32 s54, s54, s55
    v_lshl_add_u32 v13, v8, 4, s54
    v_add_u32 v12, v12, v13
    v_lshrrev_b32 v13, 3, v8
    s_lshl_b32 s54, s45, 2
    s_lshl_b32 s55, s64, 1
    s_add_u32 s54, s54, s55
    v_add_u32 v13, s54, v13
    v_mov_b32 v14, 2146435072
    v_cmp_gt_u32 vcc, 27, v13
    s_nop 1
    v_cndmask_b32 v12, v14, v12, vcc
    v_add_u32 v2, s65, v8
    v_lshlrev_b32 v2, 4, v2
    v_add_u32 v2, 149504, v2
    ds_read_b128 v[232:235], v2 offset:512
    ds_read_b128 v[236:239], v2 offset:768
    s_lshl_b32 s53, s50, 14
    v_lshlrev_b32 v13, 4, v1
    v_add_u32 v13, s53, v13
    s_barrier
    ds_read_b128 v[16:19], v13 offset:0
    ds_read_b128 v[20:23], v13 offset:1024
    ds_read_b128 v[24:27], v13 offset:2048
    ds_read_b128 v[28:31], v13 offset:3072
    ds_read_b128 v[32:35], v13 offset:4096
    ds_read_b128 v[36:39], v13 offset:5120
    ds_read_b128 v[40:43], v13 offset:6144
    ds_read_b128 v[44:47], v13 offset:7168
    ds_read_b128 v[48:51], v13 offset:8192
    ds_read_b128 v[52:55], v13 offset:9216
    ds_read_b128 v[56:59], v13 offset:10240
    ds_read_b128 v[60:63], v13 offset:11264
    s_waitcnt lgkmcnt(6)
    ds_read_b128 v[64:67], v13 offset:12288
    ds_read_b128 v[68:71], v13 offset:13312
    ds_read_b128 v[72:75], v13 offset:14336
    ds_read_b128 v[76:79], v13 offset:15360
    s_waitcnt lgkmcnt(0)
    v_pk_mul_f32 v[144:145], v[16:17], v[16:17]
    v_pk_mul_f32 v[146:147], v[18:19], v[18:19]
    v_pk_mul_f32 v[148:149], v[20:21], v[20:21]
    v_pk_mul_f32 v[150:151], v[22:23], v[22:23]
    v_pk_mul_f32 v[152:153], v[24:25], v[24:25]
    v_pk_mul_f32 v[154:155], v[26:27], v[26:27]
    v_pk_mul_f32 v[156:157], v[28:29], v[28:29]
    v_pk_mul_f32 v[158:159], v[30:31], v[30:31]
    v_pk_mul_f32 v[160:161], v[32:33], v[32:33]
    v_pk_mul_f32 v[162:163], v[34:35], v[34:35]
    v_pk_mul_f32 v[164:165], v[36:37], v[36:37]
    v_pk_mul_f32 v[166:167], v[38:39], v[38:39]
    v_pk_mul_f32 v[168:169], v[40:41], v[40:41]
    v_pk_mul_f32 v[170:171], v[42:43], v[42:43]
    v_pk_mul_f32 v[172:173], v[44:45], v[44:45]
    v_pk_mul_f32 v[174:175], v[46:47], v[46:47]
    v_pk_fma_f32 v[144:145], v[144:145], v[234:235], v[234:235] op_sel:[0,1,0] op_sel_hi:[1,1,0]
    v_pk_fma_f32 v[146:147], v[146:147], v[234:235], v[234:235] op_sel:[0,1,0] op_sel_hi:[1,1,0]
    v_pk_fma_f32 v[148:149], v[148:149], v[234:235], v[234:235] op_sel:[0,1,0] op_sel_hi:[1,1,0]
    v_pk_fma_f32 v[150:151], v[150:151], v[234:235], v[234:235] op_sel:[0,1,0] op_sel_hi:[1,1,0]
    v_pk_fma_f32 v[152:153], v[152:153], v[234:235], v[234:235] op_sel:[0,1,0] op_sel_hi:[1,1,0]
    v_pk_fma_f32 v[154:155], v[154:155], v[234:235], v[234:235] op_sel:[0,1,0] op_sel_hi:[1,1,0]
    v_pk_fma_f32 v[156:157], v[156:157], v[234:235], v[234:235] op_sel:[0,1,0] op_sel_hi:[1,1,0]
    v_pk_fma_f32 v[158:159], v[158:159], v[234:235], v[234:235] op_sel:[0,1,0] op_sel_hi:[1,1,0]
    v_pk_fma_f32 v[160:161], v[160:161], v[234:235], v[234:235] op_sel:[0,1,0] op_sel_hi:[1,1,0]
    v_pk_fma_f32 v[162:163], v[162:163], v[234:235], v[234:235] op_sel:[0,1,0] op_sel_hi:[1,1,0]
    v_pk_fma_f32 v[164:165], v[164:165], v[234:235], v[234:235] op_sel:[0,1,0] op_sel_hi:[1,1,0]
    v_pk_fma_f32 v[166:167], v[166:167], v[234:235], v[234:235] op_sel:[0,1,0] op_sel_hi:[1,1,0]
    v_pk_fma_f32 v[168:169], v[168:169], v[234:235], v[234:235] op_sel:[0,1,0] op_sel_hi:[1,1,0]
    v_pk_fma_f32 v[170:171], v[170:171], v[234:235], v[234:235] op_sel:[0,1,0] op_sel_hi:[1,1,0]
    v_pk_fma_f32 v[172:173], v[172:173], v[234:235], v[234:235] op_sel:[0,1,0] op_sel_hi:[1,1,0]
    v_pk_fma_f32 v[174:175], v[174:175], v[234:235], v[234:235] op_sel:[0,1,0] op_sel_hi:[1,1,0]
    v_pk_mul_f32 v[144:145], v[144:145], v[16:17]
    v_pk_mul_f32 v[146:147], v[146:147], v[18:19]
    v_pk_mul_f32 v[148:149], v[148:149], v[20:21]
    v_pk_mul_f32 v[150:151], v[150:151], v[22:23]
    v_pk_mul_f32 v[152:153], v[152:153], v[24:25]
    v_pk_mul_f32 v[154:155], v[154:155], v[26:27]
    v_pk_mul_f32 v[156:157], v[156:157], v[28:29]
    v_pk_mul_f32 v[158:159], v[158:159], v[30:31]
    v_pk_mul_f32 v[160:161], v[160:161], v[32:33]
    v_pk_mul_f32 v[162:163], v[162:163], v[34:35]
    v_pk_mul_f32 v[164:165], v[164:165], v[36:37]
    v_pk_mul_f32 v[166:167], v[166:167], v[38:39]
    v_pk_mul_f32 v[168:169], v[168:169], v[40:41]
    v_pk_mul_f32 v[170:171], v[170:171], v[42:43]
    v_pk_mul_f32 v[172:173], v[172:173], v[44:45]
    v_pk_mul_f32 v[174:175], v[174:175], v[46:47]
    v_exp_f32 v144, v144
    v_exp_f32 v145, v145
    v_exp_f32 v146, v146
    v_exp_f32 v147, v147
    v_exp_f32 v148, v148
    v_exp_f32 v149, v149
    v_exp_f32 v150, v150
    v_exp_f32 v151, v151
    v_exp_f32 v152, v152
    v_exp_f32 v153, v153
    v_exp_f32 v154, v154
    v_exp_f32 v155, v155
    v_exp_f32 v156, v156
    v_exp_f32 v157, v157
    v_exp_f32 v158, v158
    v_exp_f32 v159, v159
    v_exp_f32 v160, v160
    v_exp_f32 v161, v161
    v_exp_f32 v162, v162
    v_exp_f32 v163, v163
    v_exp_f32 v164, v164
    v_exp_f32 v165, v165
    v_exp_f32 v166, v166
    v_exp_f32 v167, v167
    v_exp_f32 v168, v168
    v_exp_f32 v169, v169
    v_exp_f32 v170, v170
    v_exp_f32 v171, v171
    v_exp_f32 v172, v172
    v_exp_f32 v173, v173
    v_exp_f32 v174, v174
    v_exp_f32 v175, v175
    v_pk_fma_f32 v[144:145], v[144:145], v[232:233], v[232:233] op_sel:[0,1,1] op_sel_hi:[1,1,1]
    v_pk_fma_f32 v[146:147], v[146:147], v[232:233], v[232:233] op_sel:[0,1,1] op_sel_hi:[1,1,1]
    v_pk_fma_f32 v[148:149], v[148:149], v[232:233], v[232:233] op_sel:[0,1,1] op_sel_hi:[1,1,1]
    v_pk_fma_f32 v[150:151], v[150:151], v[232:233], v[232:233] op_sel:[0,1,1] op_sel_hi:[1,1,1]
    v_pk_fma_f32 v[152:153], v[152:153], v[232:233], v[232:233] op_sel:[0,1,1] op_sel_hi:[1,1,1]
    v_pk_fma_f32 v[154:155], v[154:155], v[232:233], v[232:233] op_sel:[0,1,1] op_sel_hi:[1,1,1]
    v_pk_fma_f32 v[156:157], v[156:157], v[232:233], v[232:233] op_sel:[0,1,1] op_sel_hi:[1,1,1]
    v_pk_fma_f32 v[158:159], v[158:159], v[232:233], v[232:233] op_sel:[0,1,1] op_sel_hi:[1,1,1]
    v_pk_fma_f32 v[160:161], v[160:161], v[232:233], v[232:233] op_sel:[0,1,1] op_sel_hi:[1,1,1]
    v_pk_fma_f32 v[162:163], v[162:163], v[232:233], v[232:233] op_sel:[0,1,1] op_sel_hi:[1,1,1]
    v_pk_fma_f32 v[164:165], v[164:165], v[232:233], v[232:233] op_sel:[0,1,1] op_sel_hi:[1,1,1]
    v_pk_fma_f32 v[166:167], v[166:167], v[232:233], v[232:233] op_sel:[0,1,1] op_sel_hi:[1,1,1]
    v_pk_fma_f32 v[168:169], v[168:169], v[232:233], v[232:233] op_sel:[0,1,1] op_sel_hi:[1,1,1]
    v_pk_fma_f32 v[170:171], v[170:171], v[232:233], v[232:233] op_sel:[0,1,1] op_sel_hi:[1,1,1]
    v_pk_fma_f32 v[172:173], v[172:173], v[232:233], v[232:233] op_sel:[0,1,1] op_sel_hi:[1,1,1]
    v_pk_fma_f32 v[174:175], v[174:175], v[232:233], v[232:233] op_sel:[0,1,1] op_sel_hi:[1,1,1]
    v_rcp_f32 v144, v144
    v_rcp_f32 v145, v145
    v_rcp_f32 v146, v146
    v_rcp_f32 v147, v147
    v_rcp_f32 v148, v148
    v_rcp_f32 v149, v149
    v_rcp_f32 v150, v150
    v_rcp_f32 v151, v151
    v_rcp_f32 v152, v152
    v_rcp_f32 v153, v153
    v_rcp_f32 v154, v154
    v_rcp_f32 v155, v155
    v_rcp_f32 v156, v156
    v_rcp_f32 v157, v157
    v_rcp_f32 v158, v158
    v_rcp_f32 v159, v159
    v_rcp_f32 v160, v160
    v_rcp_f32 v161, v161
    v_rcp_f32 v162, v162
    v_rcp_f32 v163, v163
    v_rcp_f32 v164, v164
    v_rcp_f32 v165, v165
    v_rcp_f32 v166, v166
    v_rcp_f32 v167, v167
    v_rcp_f32 v168, v168
    v_rcp_f32 v169, v169
    v_rcp_f32 v170, v170
    v_rcp_f32 v171, v171
    v_rcp_f32 v172, v172
    v_rcp_f32 v173, v173
    v_rcp_f32 v174, v174
    v_rcp_f32 v175, v175
    v_pk_mul_f32 v[144:145], v[144:145], v[16:17]
    v_pk_mul_f32 v[146:147], v[146:147], v[18:19]
    v_pk_mul_f32 v[148:149], v[148:149], v[20:21]
    v_pk_mul_f32 v[150:151], v[150:151], v[22:23]
    v_pk_mul_f32 v[152:153], v[152:153], v[24:25]
    v_pk_mul_f32 v[154:155], v[154:155], v[26:27]
    v_pk_mul_f32 v[156:157], v[156:157], v[28:29]
    v_pk_mul_f32 v[158:159], v[158:159], v[30:31]
    v_pk_mul_f32 v[160:161], v[160:161], v[32:33]
    v_pk_mul_f32 v[162:163], v[162:163], v[34:35]
    v_pk_mul_f32 v[164:165], v[164:165], v[36:37]
    v_pk_mul_f32 v[166:167], v[166:167], v[38:39]
    v_pk_mul_f32 v[168:169], v[168:169], v[40:41]
    v_pk_mul_f32 v[170:171], v[170:171], v[42:43]
    v_pk_mul_f32 v[172:173], v[172:173], v[44:45]
    v_pk_mul_f32 v[174:175], v[174:175], v[46:47]
    v_cvt_pk_bf16_f32 v176, v144, v145
    v_cvt_pk_bf16_f32 v177, v146, v147
    v_cvt_pk_bf16_f32 v178, v148, v149
    v_cvt_pk_bf16_f32 v179, v150, v151
    v_cvt_pk_bf16_f32 v180, v152, v153
    v_cvt_pk_bf16_f32 v181, v154, v155
    v_cvt_pk_bf16_f32 v182, v156, v157
    v_cvt_pk_bf16_f32 v183, v158, v159
    v_cvt_pk_bf16_f32 v184, v160, v161
    v_cvt_pk_bf16_f32 v185, v162, v163
    v_cvt_pk_bf16_f32 v186, v164, v165
    v_cvt_pk_bf16_f32 v187, v166, v167
    v_cvt_pk_bf16_f32 v188, v168, v169
    v_cvt_pk_bf16_f32 v189, v170, v171
    v_cvt_pk_bf16_f32 v190, v172, v173
    v_cvt_pk_bf16_f32 v191, v174, v175
    ds_write_b64 v10, v[176:177] offset:8704
    ds_write_b64 v10, v[178:179] offset:8736
    ds_write_b64 v10, v[180:181] offset:8768
    ds_write_b64 v10, v[182:183] offset:8800
    ds_write_b64 v10, v[184:185] offset:8832
    ds_write_b64 v10, v[186:187] offset:8864
    ds_write_b64 v10, v[188:189] offset:8896
    ds_write_b64 v10, v[190:191] offset:8928
    s_waitcnt lgkmcnt(0)
    ds_read_b128 v[192:195], v11 offset:8704
    ds_read_b128 v[196:199], v11 offset:9792
    ds_read_b128 v[200:203], v11 offset:10880
    ds_read_b128 v[204:207], v11 offset:11968
    s_mov_b32 s53, 151552
    s_waitcnt lgkmcnt(3)
    buffer_store_dwordx4 v[192:195], v12, s[24:27], s53 offen sc1
    s_add_u32 s53, s53, 18944
    s_waitcnt lgkmcnt(2)
    buffer_store_dwordx4 v[196:199], v12, s[24:27], s53 offen sc1
    s_add_u32 s53, s53, 18944
    s_waitcnt lgkmcnt(1)
    buffer_store_dwordx4 v[200:203], v12, s[24:27], s53 offen sc1
    s_add_u32 s53, s53, 18944
    s_waitcnt lgkmcnt(0)
    buffer_store_dwordx4 v[204:207], v12, s[24:27], s53 offen sc1
    v_pk_mul_f32 v[144:145], v[48:49], v[48:49]
    v_pk_mul_f32 v[146:147], v[50:51], v[50:51]
    v_pk_mul_f32 v[148:149], v[52:53], v[52:53]
    v_pk_mul_f32 v[150:151], v[54:55], v[54:55]
    v_pk_mul_f32 v[152:153], v[56:57], v[56:57]
    v_pk_mul_f32 v[154:155], v[58:59], v[58:59]
    v_pk_mul_f32 v[156:157], v[60:61], v[60:61]
    v_pk_mul_f32 v[158:159], v[62:63], v[62:63]
    v_pk_mul_f32 v[160:161], v[64:65], v[64:65]
    v_pk_mul_f32 v[162:163], v[66:67], v[66:67]
    v_pk_mul_f32 v[164:165], v[68:69], v[68:69]
    v_pk_mul_f32 v[166:167], v[70:71], v[70:71]
    v_pk_mul_f32 v[168:169], v[72:73], v[72:73]
    v_pk_mul_f32 v[170:171], v[74:75], v[74:75]
    v_pk_mul_f32 v[172:173], v[76:77], v[76:77]
    v_pk_mul_f32 v[174:175], v[78:79], v[78:79]
    v_pk_fma_f32 v[144:145], v[144:145], v[238:239], v[238:239] op_sel:[0,1,0] op_sel_hi:[1,1,0]
    v_pk_fma_f32 v[146:147], v[146:147], v[238:239], v[238:239] op_sel:[0,1,0] op_sel_hi:[1,1,0]
    v_pk_fma_f32 v[148:149], v[148:149], v[238:239], v[238:239] op_sel:[0,1,0] op_sel_hi:[1,1,0]
    v_pk_fma_f32 v[150:151], v[150:151], v[238:239], v[238:239] op_sel:[0,1,0] op_sel_hi:[1,1,0]
    v_pk_fma_f32 v[152:153], v[152:153], v[238:239], v[238:239] op_sel:[0,1,0] op_sel_hi:[1,1,0]
    v_pk_fma_f32 v[154:155], v[154:155], v[238:239], v[238:239] op_sel:[0,1,0] op_sel_hi:[1,1,0]
    v_pk_fma_f32 v[156:157], v[156:157], v[238:239], v[238:239] op_sel:[0,1,0] op_sel_hi:[1,1,0]
    v_pk_fma_f32 v[158:159], v[158:159], v[238:239], v[238:239] op_sel:[0,1,0] op_sel_hi:[1,1,0]
    v_pk_fma_f32 v[160:161], v[160:161], v[238:239], v[238:239] op_sel:[0,1,0] op_sel_hi:[1,1,0]
    v_pk_fma_f32 v[162:163], v[162:163], v[238:239], v[238:239] op_sel:[0,1,0] op_sel_hi:[1,1,0]
    v_pk_fma_f32 v[164:165], v[164:165], v[238:239], v[238:239] op_sel:[0,1,0] op_sel_hi:[1,1,0]
    v_pk_fma_f32 v[166:167], v[166:167], v[238:239], v[238:239] op_sel:[0,1,0] op_sel_hi:[1,1,0]
    v_pk_fma_f32 v[168:169], v[168:169], v[238:239], v[238:239] op_sel:[0,1,0] op_sel_hi:[1,1,0]
    v_pk_fma_f32 v[170:171], v[170:171], v[238:239], v[238:239] op_sel:[0,1,0] op_sel_hi:[1,1,0]
    v_pk_fma_f32 v[172:173], v[172:173], v[238:239], v[238:239] op_sel:[0,1,0] op_sel_hi:[1,1,0]
    v_pk_fma_f32 v[174:175], v[174:175], v[238:239], v[238:239] op_sel:[0,1,0] op_sel_hi:[1,1,0]
    v_pk_mul_f32 v[144:145], v[144:145], v[48:49]
    v_pk_mul_f32 v[146:147], v[146:147], v[50:51]
    v_pk_mul_f32 v[148:149], v[148:149], v[52:53]
    v_pk_mul_f32 v[150:151], v[150:151], v[54:55]
    v_pk_mul_f32 v[152:153], v[152:153], v[56:57]
    v_pk_mul_f32 v[154:155], v[154:155], v[58:59]
    v_pk_mul_f32 v[156:157], v[156:157], v[60:61]
    v_pk_mul_f32 v[158:159], v[158:159], v[62:63]
    v_pk_mul_f32 v[160:161], v[160:161], v[64:65]
    v_pk_mul_f32 v[162:163], v[162:163], v[66:67]
    v_pk_mul_f32 v[164:165], v[164:165], v[68:69]
    v_pk_mul_f32 v[166:167], v[166:167], v[70:71]
    v_pk_mul_f32 v[168:169], v[168:169], v[72:73]
    v_pk_mul_f32 v[170:171], v[170:171], v[74:75]
    v_pk_mul_f32 v[172:173], v[172:173], v[76:77]
    v_pk_mul_f32 v[174:175], v[174:175], v[78:79]
    v_exp_f32 v144, v144
    v_exp_f32 v145, v145
    v_exp_f32 v146, v146
    v_exp_f32 v147, v147
    v_exp_f32 v148, v148
    v_exp_f32 v149, v149
    v_exp_f32 v150, v150
    v_exp_f32 v151, v151
    v_exp_f32 v152, v152
    v_exp_f32 v153, v153
    v_exp_f32 v154, v154
    v_exp_f32 v155, v155
    v_exp_f32 v156, v156
    v_exp_f32 v157, v157
    v_exp_f32 v158, v158
    v_exp_f32 v159, v159
    v_exp_f32 v160, v160
    v_exp_f32 v161, v161
    v_exp_f32 v162, v162
    v_exp_f32 v163, v163
    v_exp_f32 v164, v164
    v_exp_f32 v165, v165
    v_exp_f32 v166, v166
    v_exp_f32 v167, v167
    v_exp_f32 v168, v168
    v_exp_f32 v169, v169
    v_exp_f32 v170, v170
    v_exp_f32 v171, v171
    v_exp_f32 v172, v172
    v_exp_f32 v173, v173
    v_exp_f32 v174, v174
    v_exp_f32 v175, v175
    v_pk_fma_f32 v[144:145], v[144:145], v[236:237], v[236:237] op_sel:[0,1,1] op_sel_hi:[1,1,1]
    v_pk_fma_f32 v[146:147], v[146:147], v[236:237], v[236:237] op_sel:[0,1,1] op_sel_hi:[1,1,1]
    v_pk_fma_f32 v[148:149], v[148:149], v[236:237], v[236:237] op_sel:[0,1,1] op_sel_hi:[1,1,1]
    v_pk_fma_f32 v[150:151], v[150:151], v[236:237], v[236:237] op_sel:[0,1,1] op_sel_hi:[1,1,1]
    v_pk_fma_f32 v[152:153], v[152:153], v[236:237], v[236:237] op_sel:[0,1,1] op_sel_hi:[1,1,1]
    v_pk_fma_f32 v[154:155], v[154:155], v[236:237], v[236:237] op_sel:[0,1,1] op_sel_hi:[1,1,1]
    v_pk_fma_f32 v[156:157], v[156:157], v[236:237], v[236:237] op_sel:[0,1,1] op_sel_hi:[1,1,1]
    v_pk_fma_f32 v[158:159], v[158:159], v[236:237], v[236:237] op_sel:[0,1,1] op_sel_hi:[1,1,1]
    v_pk_fma_f32 v[160:161], v[160:161], v[236:237], v[236:237] op_sel:[0,1,1] op_sel_hi:[1,1,1]
    v_pk_fma_f32 v[162:163], v[162:163], v[236:237], v[236:237] op_sel:[0,1,1] op_sel_hi:[1,1,1]
    v_pk_fma_f32 v[164:165], v[164:165], v[236:237], v[236:237] op_sel:[0,1,1] op_sel_hi:[1,1,1]
    v_pk_fma_f32 v[166:167], v[166:167], v[236:237], v[236:237] op_sel:[0,1,1] op_sel_hi:[1,1,1]
    v_pk_fma_f32 v[168:169], v[168:169], v[236:237], v[236:237] op_sel:[0,1,1] op_sel_hi:[1,1,1]
    v_pk_fma_f32 v[170:171], v[170:171], v[236:237], v[236:237] op_sel:[0,1,1] op_sel_hi:[1,1,1]
    v_pk_fma_f32 v[172:173], v[172:173], v[236:237], v[236:237] op_sel:[0,1,1] op_sel_hi:[1,1,1]
    v_pk_fma_f32 v[174:175], v[174:175], v[236:237], v[236:237] op_sel:[0,1,1] op_sel_hi:[1,1,1]
    v_rcp_f32 v144, v144
    v_rcp_f32 v145, v145
    v_rcp_f32 v146, v146
    v_rcp_f32 v147, v147
    v_rcp_f32 v148, v148
    v_rcp_f32 v149, v149
    v_rcp_f32 v150, v150
    v_rcp_f32 v151, v151
    v_rcp_f32 v152, v152
    v_rcp_f32 v153, v153
    v_rcp_f32 v154, v154
    v_rcp_f32 v155, v155
    v_rcp_f32 v156, v156
    v_rcp_f32 v157, v157
    v_rcp_f32 v158, v158
    v_rcp_f32 v159, v159
    v_rcp_f32 v160, v160
    v_rcp_f32 v161, v161
    v_rcp_f32 v162, v162
    v_rcp_f32 v163, v163
    v_rcp_f32 v164, v164
    v_rcp_f32 v165, v165
    v_rcp_f32 v166, v166
    v_rcp_f32 v167, v167
    v_rcp_f32 v168, v168
    v_rcp_f32 v169, v169
    v_rcp_f32 v170, v170
    v_rcp_f32 v171, v171
    v_rcp_f32 v172, v172
    v_rcp_f32 v173, v173
    v_rcp_f32 v174, v174
    v_rcp_f32 v175, v175
    v_pk_mul_f32 v[144:145], v[144:145], v[48:49]
    v_pk_mul_f32 v[146:147], v[146:147], v[50:51]
    v_pk_mul_f32 v[148:149], v[148:149], v[52:53]
    v_pk_mul_f32 v[150:151], v[150:151], v[54:55]
    v_pk_mul_f32 v[152:153], v[152:153], v[56:57]
    v_pk_mul_f32 v[154:155], v[154:155], v[58:59]
    v_pk_mul_f32 v[156:157], v[156:157], v[60:61]
    v_pk_mul_f32 v[158:159], v[158:159], v[62:63]
    v_pk_mul_f32 v[160:161], v[160:161], v[64:65]
    v_pk_mul_f32 v[162:163], v[162:163], v[66:67]
    v_pk_mul_f32 v[164:165], v[164:165], v[68:69]
    v_pk_mul_f32 v[166:167], v[166:167], v[70:71]
    v_pk_mul_f32 v[168:169], v[168:169], v[72:73]
    v_pk_mul_f32 v[170:171], v[170:171], v[74:75]
    v_pk_mul_f32 v[172:173], v[172:173], v[76:77]
    v_pk_mul_f32 v[174:175], v[174:175], v[78:79]
    v_cvt_pk_bf16_f32 v176, v144, v145
    v_cvt_pk_bf16_f32 v177, v146, v147
    v_cvt_pk_bf16_f32 v178, v148, v149
    v_cvt_pk_bf16_f32 v179, v150, v151
    v_cvt_pk_bf16_f32 v180, v152, v153
    v_cvt_pk_bf16_f32 v181, v154, v155
    v_cvt_pk_bf16_f32 v182, v156, v157
    v_cvt_pk_bf16_f32 v183, v158, v159
    v_cvt_pk_bf16_f32 v184, v160, v161
    v_cvt_pk_bf16_f32 v185, v162, v163
    v_cvt_pk_bf16_f32 v186, v164, v165
    v_cvt_pk_bf16_f32 v187, v166, v167
    v_cvt_pk_bf16_f32 v188, v168, v169
    v_cvt_pk_bf16_f32 v189, v170, v171
    v_cvt_pk_bf16_f32 v190, v172, v173
    v_cvt_pk_bf16_f32 v191, v174, v175
    ds_write_b64 v10, v[176:177] offset:13056
    ds_write_b64 v10, v[178:179] offset:13088
    ds_write_b64 v10, v[180:181] offset:13120
    ds_write_b64 v10, v[182:183] offset:13152
    ds_write_b64 v10, v[184:185] offset:13184
    ds_write_b64 v10, v[186:187] offset:13216
    ds_write_b64 v10, v[188:189] offset:13248
    ds_write_b64 v10, v[190:191] offset:13280
    s_waitcnt lgkmcnt(0)
    ds_read_b128 v[192:195], v11 offset:13056
    ds_read_b128 v[196:199], v11 offset:14144
    ds_read_b128 v[200:203], v11 offset:15232
    ds_read_b128 v[204:207], v11 offset:16320
    s_mov_b32 s53, 227328
    s_waitcnt lgkmcnt(3)
    buffer_store_dwordx4 v[192:195], v12, s[24:27], s53 offen sc1
    s_add_u32 s53, s53, 18944
    s_waitcnt lgkmcnt(2)
    buffer_store_dwordx4 v[196:199], v12, s[24:27], s53 offen sc1
    s_add_u32 s53, s53, 18944
    s_waitcnt lgkmcnt(1)
    buffer_store_dwordx4 v[200:203], v12, s[24:27], s53 offen sc1
    s_add_u32 s53, s53, 18944
    s_waitcnt lgkmcnt(0)
    buffer_store_dwordx4 v[204:207], v12, s[24:27], s53 offen sc1
    s_waitcnt vmcnt(0)
    s_endpgm
k1_kernel_pq:
    s_setprio 0
    s_barrier
    v_and_b32 v8, 15, v1
    v_lshrrev_b32 v9, 4, v1
    s_lshr_b32 s54, s50, 1
    s_and_b32 s55, s50, 1
    s_add_u32 s55, s55, 2
    s_lshl_b32 s56, s54, 2
    s_add_u32 s55, s55, s56
    s_mul_i32 s53, s55, 2560
    s_add_u32 s53, s53, 65536
    v_lshlrev_b32 v13, 4, v1
    v_add_u32 v13, s53, v13
    v_lshlrev_b32 v14, 3, v1
    v_add_u32 v14, s53, v14
    ds_read_b128 v[144:147], v13
    ds_read_b128 v[148:151], v13 offset:1024
    ds_read_b64 v[152:153], v14 offset:2048
    v_mov_b32 v154, 0
    v_mov_b32 v155, 0
    s_lshl_b32 s56, s55, 4
    v_add_u32 v10, s56, v8
    v_lshlrev_b32 v11, 4, v10
    v_add_u32 v11, 149504, v11
    ds_read_b32 v168, v11
    v_mul_u32_u24 v11, 496, v10
    v_mul_u32_u24 v12, 80, v9
    v_add_u32 v12, v12, v11
    s_waitcnt lgkmcnt(0)
    v_bfe_u32 v13, v1, 2, 2
    v_and_b32 v14, 3, v1
    v_mul_u32_u24 v15, 800, v9
    v_mul_u32_u24 v13, 40, v13
    v_add_u32 v15, v15, v13
    v_add_u32 v15, 155648, v15
    v_mov_b32 v13, 159744
    v_cmp_eq_u32 vcc, v14, v9
    s_mov_b32 s57, 0x3fb8aa3b
    s_nop 0
    v_cndmask_b32 v15, v13, v15, vcc
    ds_read_b64_tr_b16 v[208:209], v15 offset:0
    ds_read_b64_tr_b16 v[210:211], v15 offset:160
    ds_read_b64_tr_b16 v[212:213], v15 offset:320
    ds_read_b64_tr_b16 v[214:215], v15 offset:480
    ds_read_b64_tr_b16 v[216:217], v15 offset:640
    v_mov_b32 v218, 0
    v_mov_b32 v219, 0
    ds_read_b64_tr_b16 v[220:221], v15 offset:8
    ds_read_b64_tr_b16 v[222:223], v15 offset:168
    s_waitcnt lgkmcnt(5)
    v_mfma_f32_16x16x32_bf16 v[16:19], v[208:211], v[144:147], 0
    ds_read_b64_tr_b16 v[208:209], v15 offset:328
    ds_read_b64_tr_b16 v[210:211], v15 offset:488
    s_waitcnt lgkmcnt(5)
    v_mfma_f32_16x16x32_bf16 v[16:19], v[212:215], v[148:151], v[16:19]
    ds_read_b64_tr_b16 v[212:213], v15 offset:648
    v_mov_b32 v214, 0
    v_mov_b32 v215, 0
    s_waitcnt lgkmcnt(5)
    s_nop 0
    v_mfma_f32_16x16x32_bf16 v[16:19], v[216:219], v[152:155], v[16:19]
    ds_read_b64_tr_b16 v[216:217], v15 offset:16
    ds_read_b64_tr_b16 v[218:219], v15 offset:176
    s_waitcnt lgkmcnt(5)
    v_mfma_f32_16x16x32_bf16 v[20:23], v[220:223], v[144:147], 0
    ds_read_b64_tr_b16 v[220:221], v15 offset:336
    ds_read_b64_tr_b16 v[222:223], v15 offset:496
    s_waitcnt lgkmcnt(5)
    v_mfma_f32_16x16x32_bf16 v[20:23], v[208:211], v[148:151], v[20:23]
    ds_read_b64_tr_b16 v[208:209], v15 offset:656
    v_mov_b32 v210, 0
    v_mov_b32 v211, 0
    s_waitcnt lgkmcnt(5)
    s_nop 0
    v_mfma_f32_16x16x32_bf16 v[20:23], v[212:215], v[152:155], v[20:23]
    ds_read_b64_tr_b16 v[212:213], v15 offset:24
    ds_read_b64_tr_b16 v[214:215], v15 offset:184
    s_waitcnt lgkmcnt(5)
    v_mfma_f32_16x16x32_bf16 v[24:27], v[216:219], v[144:147], 0
    ds_read_b64_tr_b16 v[216:217], v15 offset:344
    ds_read_b64_tr_b16 v[218:219], v15 offset:504
    s_waitcnt lgkmcnt(5)
    v_mfma_f32_16x16x32_bf16 v[24:27], v[220:223], v[148:151], v[24:27]
    ds_read_b64_tr_b16 v[220:221], v15 offset:664
    v_mov_b32 v222, 0
    v_mov_b32 v223, 0
    s_waitcnt lgkmcnt(5)
    s_nop 0
    v_mfma_f32_16x16x32_bf16 v[24:27], v[208:211], v[152:155], v[24:27]
    ds_read_b64_tr_b16 v[208:209], v15 offset:32
    ds_read_b64_tr_b16 v[210:211], v15 offset:192
    s_waitcnt lgkmcnt(5)
    v_mfma_f32_16x16x32_bf16 v[28:31], v[212:215], v[144:147], 0
    ds_read_b64_tr_b16 v[212:213], v15 offset:352
    ds_read_b64_tr_b16 v[214:215], v15 offset:512
    s_waitcnt lgkmcnt(5)
    v_mfma_f32_16x16x32_bf16 v[28:31], v[216:219], v[148:151], v[28:31]
    ds_read_b64_tr_b16 v[216:217], v15 offset:672
    v_mov_b32 v218, 0
    v_mov_b32 v219, 0
    s_waitcnt lgkmcnt(5)
    s_nop 0
    v_mfma_f32_16x16x32_bf16 v[28:31], v[220:223], v[152:155], v[28:31]
    s_waitcnt lgkmcnt(3)
    v_mfma_f32_16x16x32_bf16 v[32:35], v[208:211], v[144:147], 0
    s_waitcnt lgkmcnt(1)
    v_mfma_f32_16x16x32_bf16 v[32:35], v[212:215], v[148:151], v[32:35]
    s_waitcnt lgkmcnt(0)
    s_nop 0
    v_mfma_f32_16x16x32_bf16 v[32:35], v[216:219], v[152:155], v[32:35]
    s_nop 7
    v_max3_f32 v4, v16, v17, v18
    v_min3_f32 v5, v16, v17, v18
    v_max3_f32 v4, v4, v19, v20
    v_min3_f32 v5, v5, v19, v20
    v_max3_f32 v4, v4, v21, v22
    v_min3_f32 v5, v5, v21, v22
    v_max3_f32 v4, v4, v23, v24
    v_min3_f32 v5, v5, v23, v24
    v_max3_f32 v4, v4, v25, v26
    v_min3_f32 v5, v5, v25, v26
    v_max3_f32 v4, v4, v27, v28
    v_min3_f32 v5, v5, v27, v28
    v_max3_f32 v4, v4, v29, v30
    v_min3_f32 v5, v5, v29, v30
    v_max3_f32 v4, v4, v31, v32
    v_min3_f32 v5, v5, v31, v32
    v_max3_f32 v4, v4, v33, v34
    v_min3_f32 v5, v5, v33, v34
    v_max_f32 v4, v4, v35
    v_min_f32 v5, v5, v35
    v_mul_f32 v6, s57, v168
    v_mul_f32 v4, v4, v6
    v_mul_f32 v14, v5, v6
    v_pk_fma_f32 v[56:57], v[16:17], v[6:7], v[14:15] op_sel_hi:[1,0,0] neg_lo:[1,0,0] neg_hi:[1,0,0]
    v_pk_fma_f32 v[58:59], v[18:19], v[6:7], v[14:15] op_sel_hi:[1,0,0] neg_lo:[1,0,0] neg_hi:[1,0,0]
    v_pk_fma_f32 v[60:61], v[20:21], v[6:7], v[14:15] op_sel_hi:[1,0,0] neg_lo:[1,0,0] neg_hi:[1,0,0]
    v_pk_fma_f32 v[62:63], v[22:23], v[6:7], v[14:15] op_sel_hi:[1,0,0] neg_lo:[1,0,0] neg_hi:[1,0,0]
    v_pk_fma_f32 v[64:65], v[24:25], v[6:7], v[14:15] op_sel_hi:[1,0,0] neg_lo:[1,0,0] neg_hi:[1,0,0]
    v_pk_fma_f32 v[66:67], v[26:27], v[6:7], v[14:15] op_sel_hi:[1,0,0] neg_lo:[1,0,0] neg_hi:[1,0,0]
    v_pk_fma_f32 v[68:69], v[28:29], v[6:7], v[14:15] op_sel_hi:[1,0,0] neg_lo:[1,0,0] neg_hi:[1,0,0]
    v_pk_fma_f32 v[70:71], v[30:31], v[6:7], v[14:15] op_sel_hi:[1,0,0] neg_lo:[1,0,0] neg_hi:[1,0,0]
    v_pk_fma_f32 v[72:73], v[32:33], v[6:7], v[14:15] op_sel_hi:[1,0,0] neg_lo:[1,0,0] neg_hi:[1,0,0]
    v_pk_fma_f32 v[74:75], v[34:35], v[6:7], v[14:15] op_sel_hi:[1,0,0] neg_lo:[1,0,0] neg_hi:[1,0,0]
    v_pk_fma_f32 v[16:17], v[16:17], v[6:7], v[4:5] op_sel_hi:[1,0,0] neg_lo:[0,0,1] neg_hi:[0,0,1]
    v_pk_fma_f32 v[18:19], v[18:19], v[6:7], v[4:5] op_sel_hi:[1,0,0] neg_lo:[0,0,1] neg_hi:[0,0,1]
    v_pk_fma_f32 v[20:21], v[20:21], v[6:7], v[4:5] op_sel_hi:[1,0,0] neg_lo:[0,0,1] neg_hi:[0,0,1]
    v_pk_fma_f32 v[22:23], v[22:23], v[6:7], v[4:5] op_sel_hi:[1,0,0] neg_lo:[0,0,1] neg_hi:[0,0,1]
    v_pk_fma_f32 v[24:25], v[24:25], v[6:7], v[4:5] op_sel_hi:[1,0,0] neg_lo:[0,0,1] neg_hi:[0,0,1]
    v_pk_fma_f32 v[26:27], v[26:27], v[6:7], v[4:5] op_sel_hi:[1,0,0] neg_lo:[0,0,1] neg_hi:[0,0,1]
    v_pk_fma_f32 v[28:29], v[28:29], v[6:7], v[4:5] op_sel_hi:[1,0,0] neg_lo:[0,0,1] neg_hi:[0,0,1]
    v_pk_fma_f32 v[30:31], v[30:31], v[6:7], v[4:5] op_sel_hi:[1,0,0] neg_lo:[0,0,1] neg_hi:[0,0,1]
    v_pk_fma_f32 v[32:33], v[32:33], v[6:7], v[4:5] op_sel_hi:[1,0,0] neg_lo:[0,0,1] neg_hi:[0,0,1]
    v_pk_fma_f32 v[34:35], v[34:35], v[6:7], v[4:5] op_sel_hi:[1,0,0] neg_lo:[0,0,1] neg_hi:[0,0,1]
    v_exp_f32 v56, v56
    v_exp_f32 v57, v57
    v_exp_f32 v58, v58
    v_exp_f32 v59, v59
    v_exp_f32 v60, v60
    v_exp_f32 v61, v61
    v_exp_f32 v62, v62
    v_exp_f32 v63, v63
    v_exp_f32 v64, v64
    v_exp_f32 v65, v65
    v_exp_f32 v66, v66
    v_exp_f32 v67, v67
    v_exp_f32 v68, v68
    v_exp_f32 v69, v69
    v_exp_f32 v70, v70
    v_exp_f32 v71, v71
    v_exp_f32 v72, v72
    v_exp_f32 v73, v73
    v_exp_f32 v74, v74
    v_exp_f32 v75, v75
    v_exp_f32 v16, v16
    v_exp_f32 v17, v17
    v_exp_f32 v18, v18
    v_exp_f32 v19, v19
    v_exp_f32 v20, v20
    v_exp_f32 v21, v21
    v_exp_f32 v22, v22
    v_exp_f32 v23, v23
    v_exp_f32 v24, v24
    v_exp_f32 v25, v25
    v_exp_f32 v26, v26
    v_exp_f32 v27, v27
    v_exp_f32 v28, v28
    v_exp_f32 v29, v29
    v_exp_f32 v30, v30
    v_exp_f32 v31, v31
    v_exp_f32 v32, v32
    v_exp_f32 v33, v33
    v_exp_f32 v34, v34
    v_exp_f32 v35, v35
    v_pk_add_f32 v[4:5], v[56:57], v[58:59]
    v_pk_add_f32 v[6:7], v[16:17], v[18:19]
    v_pk_add_f32 v[4:5], v[4:5], v[60:61]
    v_pk_add_f32 v[6:7], v[6:7], v[20:21]
    v_pk_add_f32 v[4:5], v[4:5], v[62:63]
    v_pk_add_f32 v[6:7], v[6:7], v[22:23]
    v_pk_add_f32 v[4:5], v[4:5], v[64:65]
    v_pk_add_f32 v[6:7], v[6:7], v[24:25]
    v_pk_add_f32 v[4:5], v[4:5], v[66:67]
    v_pk_add_f32 v[6:7], v[6:7], v[26:27]
    v_pk_add_f32 v[4:5], v[4:5], v[68:69]
    v_pk_add_f32 v[6:7], v[6:7], v[28:29]
    v_pk_add_f32 v[4:5], v[4:5], v[70:71]
    v_pk_add_f32 v[6:7], v[6:7], v[30:31]
    v_pk_add_f32 v[4:5], v[4:5], v[72:73]
    v_pk_add_f32 v[6:7], v[6:7], v[32:33]
    v_pk_add_f32 v[4:5], v[4:5], v[74:75]
    v_pk_add_f32 v[6:7], v[6:7], v[34:35]
    v_add_f32 v4, v4, v5
    v_add_f32 v6, v6, v7
    v_rcp_f32 v4, v4
    v_rcp_f32 v6, v6
    s_nop 0
    v_pk_mul_f32 v[16:17], v[16:17], v[6:7] op_sel_hi:[1,0]
    v_pk_mul_f32 v[18:19], v[18:19], v[6:7] op_sel_hi:[1,0]
    v_pk_mul_f32 v[20:21], v[20:21], v[6:7] op_sel_hi:[1,0]
    v_pk_mul_f32 v[22:23], v[22:23], v[6:7] op_sel_hi:[1,0]
    v_pk_mul_f32 v[24:25], v[24:25], v[6:7] op_sel_hi:[1,0]
    v_pk_mul_f32 v[26:27], v[26:27], v[6:7] op_sel_hi:[1,0]
    v_pk_mul_f32 v[28:29], v[28:29], v[6:7] op_sel_hi:[1,0]
    v_pk_mul_f32 v[30:31], v[30:31], v[6:7] op_sel_hi:[1,0]
    v_pk_mul_f32 v[32:33], v[32:33], v[6:7] op_sel_hi:[1,0]
    v_pk_mul_f32 v[34:35], v[34:35], v[6:7] op_sel_hi:[1,0]
    v_pk_mul_f32 v[56:57], v[56:57], v[4:5] op_sel_hi:[1,0]
    v_pk_mul_f32 v[58:59], v[58:59], v[4:5] op_sel_hi:[1,0]
    v_pk_mul_f32 v[60:61], v[60:61], v[4:5] op_sel_hi:[1,0]
    v_pk_mul_f32 v[62:63], v[62:63], v[4:5] op_sel_hi:[1,0]
    v_pk_mul_f32 v[64:65], v[64:65], v[4:5] op_sel_hi:[1,0]
    v_pk_mul_f32 v[66:67], v[66:67], v[4:5] op_sel_hi:[1,0]
    v_pk_mul_f32 v[68:69], v[68:69], v[4:5] op_sel_hi:[1,0]
    v_pk_mul_f32 v[70:71], v[70:71], v[4:5] op_sel_hi:[1,0]
    v_pk_mul_f32 v[72:73], v[72:73], v[4:5] op_sel_hi:[1,0]
    v_pk_mul_f32 v[74:75], v[74:75], v[4:5] op_sel_hi:[1,0]
    v_cvt_pk_bf16_f32 v36, v16, v17
    v_cvt_pk_bf16_f32 v37, v18, v19
    v_cvt_pk_bf16_f32 v38, v20, v21
    v_cvt_pk_bf16_f32 v39, v22, v23
    v_cvt_pk_bf16_f32 v40, v24, v25
    v_cvt_pk_bf16_f32 v41, v26, v27
    v_cvt_pk_bf16_f32 v42, v28, v29
    v_cvt_pk_bf16_f32 v43, v30, v31
    v_cvt_pk_bf16_f32 v44, v32, v33
    v_cvt_pk_bf16_f32 v45, v34, v35
    v_cvt_pk_bf16_f32 v46, v56, v57
    v_cvt_pk_bf16_f32 v47, v58, v59
    v_cvt_pk_bf16_f32 v48, v60, v61
    v_cvt_pk_bf16_f32 v49, v62, v63
    v_cvt_pk_bf16_f32 v50, v64, v65
    v_cvt_pk_bf16_f32 v51, v66, v67
    v_cvt_pk_bf16_f32 v52, v68, v69
    v_cvt_pk_bf16_f32 v53, v70, v71
    v_cvt_pk_bf16_f32 v54, v72, v73
    v_cvt_pk_bf16_f32 v55, v74, v75
    ds_write_b128 v12, v[36:39] offset:0
    ds_write_b128 v12, v[40:43] offset:16
    ds_write_b128 v12, v[44:47] offset:32
    ds_write_b128 v12, v[48:51] offset:48
    ds_write_b128 v12, v[52:55] offset:64
    s_waitcnt lgkmcnt(0)
    s_barrier
    v_and_b32 v8, 15, v1
    v_lshrrev_b32 v9, 4, v1
    s_lshr_b32 s52, s40, 1
    s_and_b32 s53, s40, 1
    v_bfe_u32 v13, v1, 2, 2
    v_and_b32 v14, 3, v1
    v_lshl_add_u32 v13, v9, 3, v13
    v_mul_u32_u24 v13, 496, v13
    s_mul_i32 s54, s52, 40
    s_add_u32 s54, s54, 320
    v_lshl_add_u32 v15, v14, 3, s54
    s_add_u32 s54, s54, 32
    v_mov_b32 v2, 480
    v_mov_b32 v3, s54
    v_cmp_eq_u32 vcc, 0, v14
    s_nop 1
    v_cndmask_b32 v2, v2, v3, vcc
    s_cmp_eq_u32 s53, 0
    s_cselect_b64 vcc, -1, 0
    s_nop 1
    v_cndmask_b32 v15, v2, v15, vcc
    v_add_u32 v2, v13, v15
    s_mul_i32 s54, s52, 80
    v_lshl_add_u32 v3, v14, 3, s54
    v_add_u32 v3, v3, v13
    v_and_b32 v4, 1, v14
    v_lshl_add_u32 v4, v4, 3, s54
    v_add3_u32 v4, v4, v13, 64
    ds_read_b64_tr_b16 v[32:33], v2 offset:0
    ds_read_b64_tr_b16 v[34:35], v2 offset:1984
    ds_read_b64_tr_b16 v[36:37], v3 offset:0
    ds_read_b64_tr_b16 v[38:39], v3 offset:1984
    ds_read_b64_tr_b16 v[40:41], v3 offset:32
    ds_read_b64_tr_b16 v[42:43], v3 offset:2016
    ds_read_b64_tr_b16 v[44:45], v4 offset:0
    ds_read_b64_tr_b16 v[46:47], v4 offset:1984
    ds_read_b64_tr_b16 v[48:49], v2 offset:15872
    ds_read_b64_tr_b16 v[50:51], v2 offset:17856
    ds_read_b64_tr_b16 v[52:53], v3 offset:15872
    ds_read_b64_tr_b16 v[54:55], v3 offset:17856
    ds_read_b64_tr_b16 v[56:57], v3 offset:15904
    ds_read_b64_tr_b16 v[58:59], v3 offset:17888
    ds_read_b64_tr_b16 v[60:61], v4 offset:15872
    ds_read_b64_tr_b16 v[62:63], v4 offset:17856
    s_waitcnt lgkmcnt(8)
    ds_read_b64_tr_b16 v[64:65], v2 offset:31744
    ds_read_b64_tr_b16 v[66:67], v2 offset:33728
    ds_read_b64_tr_b16 v[68:69], v3 offset:31744
    ds_read_b64_tr_b16 v[70:71], v3 offset:33728
    ds_read_b64_tr_b16 v[72:73], v3 offset:31776
    ds_read_b64_tr_b16 v[74:75], v3 offset:33760
    ds_read_b64_tr_b16 v[76:77], v4 offset:31744
    ds_read_b64_tr_b16 v[78:79], v4 offset:33728
    v_mfma_f32_16x16x32_bf16 v[16:19], v[32:35], v[36:39], 0
    v_mfma_f32_16x16x32_bf16 v[20:23], v[32:35], v[40:43], 0
    v_mfma_f32_16x16x32_bf16 v[24:27], v[32:35], v[44:47], 0
    s_waitcnt lgkmcnt(8)
    ds_read_b64_tr_b16 v[80:81], v2 offset:47616
    ds_read_b64_tr_b16 v[82:83], v2 offset:49600
    ds_read_b64_tr_b16 v[84:85], v3 offset:47616
    ds_read_b64_tr_b16 v[86:87], v3 offset:49600
    ds_read_b64_tr_b16 v[88:89], v3 offset:47648
    ds_read_b64_tr_b16 v[90:91], v3 offset:49632
    ds_read_b64_tr_b16 v[92:93], v4 offset:47616
    ds_read_b64_tr_b16 v[94:95], v4 offset:49600
    v_mfma_f32_16x16x32_bf16 v[16:19], v[48:51], v[52:55], v[16:19]
    v_mfma_f32_16x16x32_bf16 v[20:23], v[48:51], v[56:59], v[20:23]
    v_mfma_f32_16x16x32_bf16 v[24:27], v[48:51], v[60:63], v[24:27]
    s_waitcnt lgkmcnt(8)
    v_mfma_f32_16x16x32_bf16 v[16:19], v[64:67], v[68:71], v[16:19]
    v_mfma_f32_16x16x32_bf16 v[20:23], v[64:67], v[72:75], v[20:23]
    v_mfma_f32_16x16x32_bf16 v[24:27], v[64:67], v[76:79], v[24:27]
    s_waitcnt lgkmcnt(0)
    v_mfma_f32_16x16x32_bf16 v[16:19], v[80:83], v[84:87], v[16:19]
    v_mfma_f32_16x16x32_bf16 v[20:23], v[80:83], v[88:91], v[20:23]
    v_mfma_f32_16x16x32_bf16 v[24:27], v[80:83], v[92:95], v[24:27]
    s_lshl_b32 s54, s42, 5
    s_lshl_b32 s55, s45, 2
    s_add_u32 s54, s54, s55
    s_add_u32 s54, s54, s52
    s_mul_i32 s54, s54, 3840
    s_mul_i32 s55, s53, 2560
    s_add_u32 s54, s54, s55
    s_add_u32 s54, s54, 25165824
    v_mul_u32_u24 v13, 640, v9
    v_lshl_add_u32 v13, v8, 2, v13
    v_add_u32 v13, s54, v13
    v_mov_b32 v14, 2146435072
    v_cmp_gt_u32 vcc, 2, v9
    s_cmp_eq_u32 s53, 0
    s_cselect_b64 s[56:57], -1, 0
    s_nop 1
    s_or_b64 vcc, vcc, s[56:57]
    s_nop 1
    v_cndmask_b32 v13, v14, v13, vcc
    v_cmp_gt_u32 vcc, 8, v8
    s_nop 1
    v_cndmask_b32 v15, v14, v13, vcc
    s_nop 3
    buffer_store_dword v16, v13, s[24:27], 0 offen offset:0
    buffer_store_dword v17, v13, s[24:27], 0 offen offset:160
    buffer_store_dword v18, v13, s[24:27], 0 offen offset:320
    buffer_store_dword v19, v13, s[24:27], 0 offen offset:480
    buffer_store_dword v20, v13, s[24:27], 0 offen offset:64
    buffer_store_dword v21, v13, s[24:27], 0 offen offset:224
    buffer_store_dword v22, v13, s[24:27], 0 offen offset:384
    buffer_store_dword v23, v13, s[24:27], 0 offen offset:544
    buffer_store_dword v24, v15, s[24:27], 0 offen offset:128
    buffer_store_dword v25, v15, s[24:27], 0 offen offset:288
    buffer_store_dword v26, v15, s[24:27], 0 offen offset:448
    buffer_store_dword v27, v15, s[24:27], 0 offen offset:608
    s_waitcnt vmcnt(0)
    s_endpgm
k1_kernel_cons:
    s_cmp_eq_u32 s44, 0
    s_cbranch_scc1 k1_kernel_cq
    s_cmp_eq_u32 s40, 3
    s_cbranch_scc0 k1_kernel_w_nocp
    s_getpc_b64 s[68:69]
k1_kernel_pcw:
    s_sub_u32 s68, s68, k1_kernel_pcw-k1_kernel
    s_subb_u32 s69, s69, 0
    s_lshr_b32 s70, s2, 3
    s_lshl_b32 s70, s70, 4
    v_add_u32 v240, s70, v1
    v_lshlrev_b32 v240, 7, v240
    s_mov_b32 s70, code_end-k1_kernel-4
    v_min_u32 v240, s70, v240
    v_mov_b32 v241, s69
    v_add_co_u32 v240, vcc, s68, v240
    v_addc_co_u32 v241, vcc, 0, v241, vcc
    s_mov_b64 exec, 0xffff
    global_load_dword v242, v[240:241], off
    s_mov_b64 exec, -1
k1_kernel_w_nocp:
    s_waitcnt lgkmcnt(0)
    s_mov_b32 s16, s4
    s_mov_b32 s17, s5
    s_mov_b32 s18, 2621440
    s_mov_b32 s19, 0x20000
    s_cmp_eq_u32 s44, 0
    s_cselect_b32 s20, s6, s12
    s_cselect_b32 s21, s7, s13
    s_mov_b32 s22, 2457600
    s_cselect_b32 s22, s22, 2211840
    s_mov_b32 s23, 0x20000
    s_mov_b32 s24, s10
    s_mov_b32 s25, s11
    s_mov_b32 s26, 33554432
    s_mov_b32 s27, 0x20000
    s_mov_b32 s28, s8
    s_mov_b32 s29, s9
    s_mov_b32 s30, 25600
    s_mov_b32 s31, 0x20000
    s_mov_b32 s32, s14
    s_mov_b32 s33, s15
    s_mov_b32 s34, 3456
    s_mov_b32 s35, 0x20000
    s_lshr_b32 s50, s40, 1
    s_and_b32 s51, s40, 1
    s_lshl_b32 s52, s50, 6
    v_and_b32 v8, 15, v1
    v_lshrrev_b32 v9, 4, v1
    v_lshrrev_b32 v10, 1, v8
    v_xor_b32 v10, v10, v9
    v_lshlrev_b32 v10, 4, v10
    v_add_u32 v11, s52, v8
    v_lshl_add_u32 v2, v11, 7, v10
    v_add_u32 v2, 98304, v2
    v_xor_b32 v3, 64, v2
    v_bfe_u32 v10, v1, 2, 2
    v_and_b32 v11, 3, v1
    v_and_b32 v12, 1, v9
    v_lshl_add_u32 v12, v12, 2, v10
    v_lshlrev_b32 v12, 2, v12
    v_lshl_add_u32 v13, v9, 3, v10
    v_lshlrev_b32 v13, 9, v13
    s_lshl_b32 s53, s51, 5
    v_add_u32 v15, s53, v11
    v_add_u32 v15, 0, v15
    v_xor_b32 v15, v15, v12
    v_lshl_add_u32 v208, v15, 3, v13
    v_add_u32 v15, s53, v11
    v_add_u32 v15, 4, v15
    v_xor_b32 v15, v15, v12
    v_lshl_add_u32 v209, v15, 3, v13
    v_add_u32 v15, s53, v11
    v_add_u32 v15, 8, v15
    v_xor_b32 v15, v15, v12
    v_lshl_add_u32 v210, v15, 3, v13
    v_add_u32 v15, s53, v11
    v_add_u32 v15, 12, v15
    v_xor_b32 v15, v15, v12
    v_lshl_add_u32 v211, v15, 3, v13
    v_add_u32 v15, s53, v11
    v_add_u32 v15, 16, v15
    v_xor_b32 v15, v15, v12
    v_lshl_add_u32 v212, v15, 3, v13
    v_add_u32 v15, s53, v11
    v_add_u32 v15, 20, v15
    v_xor_b32 v15, v15, v12
    v_lshl_add_u32 v213, v15, 3, v13
    v_add_u32 v15, s53, v11
    v_add_u32 v15, 24, v15
    v_xor_b32 v15, v15, v12
    v_lshl_add_u32 v214, v15, 3, v13
    v_add_u32 v15, s53, v11
    v_add_u32 v15, 28, v15
    v_xor_b32 v15, v15, v12
    v_lshl_add_u32 v215, v15, 3, v13
    v_mov_b32 v16, 0
    v_mov_b32 v17, 0
    v_mov_b32 v18, 0
    v_mov_b32 v19, 0
    v_mov_b32 v20, 0
    v_mov_b32 v21, 0
    v_mov_b32 v22, 0
    v_mov_b32 v23, 0
    v_mov_b32 v24, 0
    v_mov_b32 v25, 0
    v_mov_b32 v26, 0
    v_mov_b32 v27, 0
    v_mov_b32 v28, 0
    v_mov_b32 v29, 0
    v_mov_b32 v30, 0
    v_mov_b32 v31, 0
    v_mov_b32 v32, 0
    v_mov_b32 v33, 0
    v_mov_b32 v34, 0
    v_mov_b32 v35, 0
    v_mov_b32 v36, 0
    v_mov_b32 v37, 0
    v_mov_b32 v38, 0
    v_mov_b32 v39, 0
    v_mov_b32 v40, 0
    v_mov_b32 v41, 0
    v_mov_b32 v42, 0
    v_mov_b32 v43, 0
    v_mov_b32 v44, 0
    v_mov_b32 v45, 0
    v_mov_b32 v46, 0
    v_mov_b32 v47, 0
    v_mov_b32 v48, 0
    v_mov_b32 v49, 0
    v_mov_b32 v50, 0
    v_mov_b32 v51, 0
    v_mov_b32 v52, 0
    v_mov_b32 v53, 0
    v_mov_b32 v54, 0
    v_mov_b32 v55, 0
    v_mov_b32 v56, 0
    v_mov_b32 v57, 0
    v_mov_b32 v58, 0
    v_mov_b32 v59, 0
    v_mov_b32 v60, 0
    v_mov_b32 v61, 0
    v_mov_b32 v62, 0
    v_mov_b32 v63, 0
    v_mov_b32 v64, 0
    v_mov_b32 v65, 0
    v_mov_b32 v66, 0
    v_mov_b32 v67, 0
    v_mov_b32 v68, 0
    v_mov_b32 v69, 0
    v_mov_b32 v70, 0
    v_mov_b32 v71, 0
    v_mov_b32 v72, 0
    v_mov_b32 v73, 0
    v_mov_b32 v74, 0
    v_mov_b32 v75, 0
    v_mov_b32 v76, 0
    v_mov_b32 v77, 0
    v_mov_b32 v78, 0
    v_mov_b32 v79, 0
    v_mov_b32 v80, 0
    v_mov_b32 v81, 0
    v_mov_b32 v82, 0
    v_mov_b32 v83, 0
    v_mov_b32 v84, 0
    v_mov_b32 v85, 0
    v_mov_b32 v86, 0
    v_mov_b32 v87, 0
    v_mov_b32 v88, 0
    v_mov_b32 v89, 0
    v_mov_b32 v90, 0
    v_mov_b32 v91, 0
    v_mov_b32 v92, 0
    v_mov_b32 v93, 0
    v_mov_b32 v94, 0
    v_mov_b32 v95, 0
    v_mov_b32 v96, 0
    v_mov_b32 v97, 0
    v_mov_b32 v98, 0
    v_mov_b32 v99, 0
    v_mov_b32 v100, 0
    v_mov_b32 v101, 0
    v_mov_b32 v102, 0
    v_mov_b32 v103, 0
    v_mov_b32 v104, 0
    v_mov_b32 v105, 0
    v_mov_b32 v106, 0
    v_mov_b32 v107, 0
    v_mov_b32 v108, 0
    v_mov_b32 v109, 0
    v_mov_b32 v110, 0
    v_mov_b32 v111, 0
    v_mov_b32 v112, 0
    v_mov_b32 v113, 0
    v_mov_b32 v114, 0
    v_mov_b32 v115, 0
    v_mov_b32 v116, 0
    v_mov_b32 v117, 0
    v_mov_b32 v118, 0
    v_mov_b32 v119, 0
    v_mov_b32 v120, 0
    v_mov_b32 v121, 0
    v_mov_b32 v122, 0
    v_mov_b32 v123, 0
    v_mov_b32 v124, 0
    v_mov_b32 v125, 0
    v_mov_b32 v126, 0
    v_mov_b32 v127, 0
    v_mov_b32 v128, 0
    v_mov_b32 v129, 0
    v_mov_b32 v130, 0
    v_mov_b32 v131, 0
    v_mov_b32 v132, 0
    v_mov_b32 v133, 0
    v_mov_b32 v134, 0
    v_mov_b32 v135, 0
    v_mov_b32 v136, 0
    v_mov_b32 v137, 0
    v_mov_b32 v138, 0
    v_mov_b32 v139, 0
    v_mov_b32 v140, 0
    v_mov_b32 v141, 0
    v_mov_b32 v142, 0
    v_mov_b32 v143, 0
    s_mov_b32 s54, 0
    s_mov_b32 s55, 0
    s_mov_b32 s56, 0
    v_mov_b32 v196, 0
    v_mov_b32 v197, 0
    s_mov_b32 s70, 0x3f803f80
    s_waitcnt vmcnt(5)
    v_dot2_f32_bf16 v196, v156, s70, v196
    v_dot2_f32_bf16 v197, v156, v156, v197
    v_dot2_f32_bf16 v196, v157, s70, v196
    v_dot2_f32_bf16 v197, v157, v157, v197
    v_dot2_f32_bf16 v196, v158, s70, v196
    v_dot2_f32_bf16 v197, v158, v158, v197
    v_dot2_f32_bf16 v196, v159, s70, v196
    v_dot2_f32_bf16 v197, v159, v159, v197
    v_dot2_f32_bf16 v196, v160, s70, v196
    v_dot2_f32_bf16 v197, v160, v160, v197
    v_dot2_f32_bf16 v196, v161, s70, v196
    v_dot2_f32_bf16 v197, v161, v161, v197
    v_dot2_f32_bf16 v196, v162, s70, v196
    v_dot2_f32_bf16 v197, v162, v162, v197
    v_dot2_f32_bf16 v196, v163, s70, v196
    v_dot2_f32_bf16 v197, v163, v163, v197
    v_dot2_f32_bf16 v196, v164, s70, v196
    v_dot2_f32_bf16 v197, v164, v164, v197
    v_dot2_f32_bf16 v196, v165, s70, v196
    v_dot2_f32_bf16 v197, v165, v165, v197
    v_dot2_f32_bf16 v196, v166, s70, v196
    v_dot2_f32_bf16 v197, v166, v166, v197
    v_dot2_f32_bf16 v196, v167, s70, v196
    v_dot2_f32_bf16 v197, v167, v167, v197
    v_dot2_f32_bf16 v196, v168, s70, v196
    v_dot2_f32_bf16 v197, v168, v168, v197
    v_dot2_f32_bf16 v196, v169, s70, v196
    v_dot2_f32_bf16 v197, v169, v169, v197
    v_dot2_f32_bf16 v196, v170, s70, v196
    v_dot2_f32_bf16 v197, v170, v170, v197
    v_dot2_f32_bf16 v196, v171, s70, v196
    v_dot2_f32_bf16 v197, v171, v171, v197
    v_dot2_f32_bf16 v196, v172, s70, v196
    v_dot2_f32_bf16 v197, v172, v172, v197
    v_dot2_f32_bf16 v196, v173, s70, v196
    v_dot2_f32_bf16 v197, v173, v173, v197
    v_dot2_f32_bf16 v196, v174, s70, v196
    v_dot2_f32_bf16 v197, v174, v174, v197
    v_dot2_f32_bf16 v196, v175, s70, v196
    v_dot2_f32_bf16 v197, v175, v175, v197
    s_nop 1
    v_add_f32_dpp v196, v196, v196 row_ror:8 row_mask:0xf bank_mask:0xf
    v_add_f32_dpp v197, v197, v197 row_ror:8 row_mask:0xf bank_mask:0xf
    s_nop 1
    v_add_f32_dpp v196, v196, v196 row_ror:4 row_mask:0xf bank_mask:0xf
    v_add_f32_dpp v197, v197, v197 row_ror:4 row_mask:0xf bank_mask:0xf
    s_nop 1
    v_add_f32_dpp v196, v196, v196 row_ror:2 row_mask:0xf bank_mask:0xf
    v_add_f32_dpp v197, v197, v197 row_ror:2 row_mask:0xf bank_mask:0xf
    s_nop 1
    v_add_f32_dpp v196, v196, v196 row_ror:1 row_mask:0xf bank_mask:0xf
    v_add_f32_dpp v197, v197, v197 row_ror:1 row_mask:0xf bank_mask:0xf
    s_mov_b32 s71, 0x3acccccd
    s_mov_b32 s72, 0x3727c5ac
    v_mul_f32 v196, s71, v196
    v_mul_f32 v197, s71, v197
    v_fma_f32 v197, -v196, v196, v197
    v_max_f32 v197, 0, v197
    v_add_f32 v198, s72, v197
    v_rsq_f32 v199, v198
    s_nop 0
    v_mul_f32 v200, v199, v199
    v_mul_f32 v200, v200, v197
    v_add_f32 v200, s72, v200
    v_rsq_f32 v200, v200
    s_nop 0
    v_mul_f32 v203, v199, v200
    v_rcp_f32 v201, v203
    v_sub_f32 v204, 0, v196
    v_and_b32 v205, 0xffff0000, v204
    v_sub_f32 v206, v204, v205
    v_cvt_pk_bf16_f32 v200, v205, v206
    v_and_b32 v205, 0xffff0000, v201
    v_sub_f32 v206, v201, v205
    v_cvt_pk_bf16_f32 v201, v205, v206
    v_mov_b32 v202, v199
    v_lshlrev_b32 v151, 4, v146
    v_add_u32 v151, 29360128, v151
    v_mov_b32 v152, 2048
    v_cmp_eq_u32 vcc, 0, v145
    v_cmp_gt_u32 s[74:75], 9, v144
    v_cmp_lt_u32 s[76:77], v146, v152
    s_nop 1
    s_and_b64 vcc, vcc, s[74:75]
    s_and_b64 vcc, vcc, s[76:77]
    s_nop 1
    v_cndmask_b32 v151, v148, v151, vcc
    s_waitcnt vmcnt(0)
    buffer_store_dwordx4 v[200:203], v151, s[24:27], 0 offen sc1
    v_mov_b32 v156, 0
    v_mov_b32 v157, 0
    v_mov_b32 v158, 0
    v_mov_b32 v159, 0
    v_mov_b32 v160, 0
    v_mov_b32 v161, 0
    v_mov_b32 v162, 0
    v_mov_b32 v163, 0
    s_mov_b32 s70, 0x00003f80
    s_mov_b32 s71, 0x3f800000
    s_waitcnt vmcnt(63)
    v_dot2_f32_bf16 v156, v176, s70, v156
    v_dot2_f32_bf16 v157, v176, s71, v157
    v_dot2_f32_bf16 v158, v177, s70, v158
    v_dot2_f32_bf16 v159, v177, s71, v159
    v_dot2_f32_bf16 v160, v178, s70, v160
    v_dot2_f32_bf16 v161, v178, s71, v161
    v_dot2_f32_bf16 v162, v179, s70, v162
    v_dot2_f32_bf16 v163, v179, s71, v163
    v_dot2_f32_bf16 v156, v180, s70, v156
    v_dot2_f32_bf16 v157, v180, s71, v157
    v_dot2_f32_bf16 v158, v181, s70, v158
    v_dot2_f32_bf16 v159, v181, s71, v159
    v_dot2_f32_bf16 v160, v182, s70, v160
    v_dot2_f32_bf16 v161, v182, s71, v161
    v_dot2_f32_bf16 v162, v183, s70, v162
    v_dot2_f32_bf16 v163, v183, s71, v163
    v_dot2_f32_bf16 v156, v184, s70, v156
    v_dot2_f32_bf16 v157, v184, s71, v157
    v_dot2_f32_bf16 v158, v185, s70, v158
    v_dot2_f32_bf16 v159, v185, s71, v159
    v_dot2_f32_bf16 v160, v186, s70, v160
    v_dot2_f32_bf16 v161, v186, s71, v161
    v_dot2_f32_bf16 v162, v187, s70, v162
    v_dot2_f32_bf16 v163, v187, s71, v163
    v_dot2_f32_bf16 v156, v188, s70, v156
    v_dot2_f32_bf16 v157, v188, s71, v157
    v_dot2_f32_bf16 v158, v189, s70, v158
    v_dot2_f32_bf16 v159, v189, s71, v159
    v_dot2_f32_bf16 v160, v190, s70, v160
    v_dot2_f32_bf16 v161, v190, s71, v161
    v_dot2_f32_bf16 v162, v191, s70, v162
    v_dot2_f32_bf16 v163, v191, s71, v163
    v_dot2_f32_bf16 v156, v192, s70, v156
    v_dot2_f32_bf16 v157, v192, s71, v157
    v_dot2_f32_bf16 v158, v193, s70, v158
    v_dot2_f32_bf16 v159, v193, s71, v159
    v_dot2_f32_bf16 v160, v194, s70, v160
    v_dot2_f32_bf16 v161, v194, s71, v161
    v_dot2_f32_bf16 v162, v195, s70, v162
    v_dot2_f32_bf16 v163, v195, s71, v163
    s_lshl_b32 s67, s40, 11
    s_add_u32 s67, s67, 147456
    v_lshlrev_b32 v153, 5, v1
    v_add_u32 v153, s67, v153
    ds_write_b128 v153, v[156:159]
    ds_write_b128 v153, v[160:163] offset:16
    v_lshlrev_b32 v154, 2, v1
    v_add_u32 v154, s67, v154
    s_waitcnt lgkmcnt(0)
    ds_read_b32 v164, v154 offset:0
    ds_read_b32 v165, v154 offset:256
    ds_read_b32 v166, v154 offset:512
    ds_read_b32 v167, v154 offset:768
    ds_read_b32 v168, v154 offset:1024
    ds_read_b32 v169, v154 offset:1280
    ds_read_b32 v170, v154 offset:1536
    ds_read_b32 v171, v154 offset:1792
    s_lshl_b32 s67, s63, 6
    v_add_u32 v155, s67, v1
    v_lshlrev_b32 v155, 2, v155
    s_lshl_b32 s67, s64, 2
    s_add_u32 s67, s67, s40
    s_mul_i32 s67, s67, 14848
    s_add_u32 s67, s67, 29884416
    s_cmp_lt_u32 s82, 228
    s_cselect_b32 s67, s67, 2146435072
    v_add_u32 v155, s67, v155
    s_waitcnt lgkmcnt(0)
    v_add_f32 v164, v164, v165
    v_add_f32 v164, v164, v166
    v_add_f32 v164, v164, v167
    v_add_f32 v164, v164, v168
    v_add_f32 v164, v164, v169
    v_add_f32 v164, v164, v170
    v_add_f32 v164, v164, v171
    buffer_store_dword v164, v155, s[24:27], 0 offen sc1
    s_barrier
    v_mov_b32 v4, v2
    v_mov_b32 v5, v3
    v_mov_b32 v216, v208
    v_mov_b32 v217, v209
    v_mov_b32 v218, v210
    v_mov_b32 v219, v211
    v_mov_b32 v220, v212
    v_mov_b32 v221, v213
    v_mov_b32 v222, v214
    v_mov_b32 v223, v215
    ds_read_b128 v[144:147], v4 offset:0
    ds_read_b64_tr_b16 v[176:177], v216 offset:0
    ds_read_b64_tr_b16 v[178:179], v216 offset:2048
    ds_read_b128 v[148:151], v4 offset:2048
    ds_read_b128 v[152:155], v4 offset:4096
    ds_read_b128 v[156:159], v4 offset:6144
    ds_read_b64_tr_b16 v[180:181], v217 offset:0
    ds_read_b64_tr_b16 v[182:183], v217 offset:2048
    ds_read_b64_tr_b16 v[184:185], v218 offset:0
    ds_read_b64_tr_b16 v[186:187], v218 offset:2048
    ds_read_b64_tr_b16 v[188:189], v219 offset:0
    ds_read_b64_tr_b16 v[190:191], v219 offset:2048
    ds_read_b64_tr_b16 v[192:193], v220 offset:0
    ds_read_b64_tr_b16 v[194:195], v220 offset:2048
    s_mov_b32 s60, 9
k1_kernel_w_loop:
    s_waitcnt lgkmcnt(11)
    v_mfma_f32_16x16x32_bf16 v[16:19], v[176:179], v[144:147], v[16:19]
    ds_read_b64_tr_b16 v[196:197], v221 offset:0
    ds_read_b64_tr_b16 v[198:199], v221 offset:2048
    s_waitcnt lgkmcnt(12)
    v_mfma_f32_16x16x32_bf16 v[20:23], v[176:179], v[148:151], v[20:23]
    s_add_u32 s56, s56, 1
    s_cmp_eq_u32 s56, 3
    s_waitcnt lgkmcnt(11)
    v_mfma_f32_16x16x32_bf16 v[24:27], v[176:179], v[152:155], v[24:27]
    s_cselect_b32 s58, 98304, 0
    s_cselect_b32 s59, 49152, 0
    s_waitcnt lgkmcnt(10)
    v_mfma_f32_16x16x32_bf16 v[28:31], v[176:179], v[156:159], v[28:31]
    s_cselect_b32 s56, 0, s56
    s_waitcnt lgkmcnt(8)
    v_mfma_f32_16x16x32_bf16 v[32:35], v[180:183], v[144:147], v[32:35]
    ds_read_b64_tr_b16 v[200:201], v222 offset:0
    v_mfma_f32_16x16x32_bf16 v[36:39], v[180:183], v[148:151], v[36:39]
    ds_read_b64_tr_b16 v[202:203], v222 offset:2048
    v_mfma_f32_16x16x32_bf16 v[40:43], v[180:183], v[152:155], v[40:43]
    ds_read_b128 v[160:163], v5 offset:0
    v_mfma_f32_16x16x32_bf16 v[44:47], v[180:183], v[156:159], v[44:47]
    s_waitcnt lgkmcnt(9)
    v_mfma_f32_16x16x32_bf16 v[48:51], v[184:187], v[144:147], v[48:51]
    ds_read_b64_tr_b16 v[204:205], v223 offset:0
    v_mfma_f32_16x16x32_bf16 v[52:55], v[184:187], v[148:151], v[52:55]
    ds_read_b64_tr_b16 v[206:207], v223 offset:2048
    v_mfma_f32_16x16x32_bf16 v[56:59], v[184:187], v[152:155], v[56:59]
    ds_read_b128 v[164:167], v5 offset:2048
    v_mfma_f32_16x16x32_bf16 v[60:63], v[184:187], v[156:159], v[60:63]
    s_waitcnt lgkmcnt(10)
    v_mfma_f32_16x16x32_bf16 v[64:67], v[188:191], v[144:147], v[64:67]
    ds_read_b64_tr_b16 v[176:177], v216 offset:16384
    v_mfma_f32_16x16x32_bf16 v[68:71], v[188:191], v[148:151], v[68:71]
    ds_read_b64_tr_b16 v[178:179], v216 offset:18432
    v_mfma_f32_16x16x32_bf16 v[72:75], v[188:191], v[152:155], v[72:75]
    ds_read_b128 v[168:171], v5 offset:4096
    v_mfma_f32_16x16x32_bf16 v[76:79], v[188:191], v[156:159], v[76:79]
    s_waitcnt lgkmcnt(11)
    v_mfma_f32_16x16x32_bf16 v[80:83], v[192:195], v[144:147], v[80:83]
    ds_read_b64_tr_b16 v[180:181], v217 offset:16384
    v_mfma_f32_16x16x32_bf16 v[84:87], v[192:195], v[148:151], v[84:87]
    ds_read_b64_tr_b16 v[182:183], v217 offset:18432
    v_mfma_f32_16x16x32_bf16 v[88:91], v[192:195], v[152:155], v[88:91]
    ds_read_b128 v[172:175], v5 offset:6144
    v_mfma_f32_16x16x32_bf16 v[92:95], v[192:195], v[156:159], v[92:95]
    s_waitcnt lgkmcnt(12)
    v_mfma_f32_16x16x32_bf16 v[96:99], v[196:199], v[144:147], v[96:99]
    ds_read_b64_tr_b16 v[184:185], v218 offset:16384
    ds_read_b64_tr_b16 v[186:187], v218 offset:18432
    v_mfma_f32_16x16x32_bf16 v[100:103], v[196:199], v[148:151], v[100:103]
    s_add_u32 s54, s54, 32768
    s_sub_u32 s54, s54, s58
    v_mfma_f32_16x16x32_bf16 v[104:107], v[196:199], v[152:155], v[104:107]
    s_add_u32 s55, s55, 16384
    s_sub_u32 s55, s55, s59
    v_mfma_f32_16x16x32_bf16 v[108:111], v[196:199], v[156:159], v[108:111]
    s_waitcnt lgkmcnt(12)
    v_mfma_f32_16x16x32_bf16 v[112:115], v[200:203], v[144:147], v[112:115]
    ds_read_b64_tr_b16 v[188:189], v219 offset:16384
    v_mfma_f32_16x16x32_bf16 v[116:119], v[200:203], v[148:151], v[116:119]
    ds_read_b64_tr_b16 v[190:191], v219 offset:18432
    v_mfma_f32_16x16x32_bf16 v[120:123], v[200:203], v[152:155], v[120:123]
    v_add_u32 v216, s54, v208
    v_mfma_f32_16x16x32_bf16 v[124:127], v[200:203], v[156:159], v[124:127]
    s_waitcnt lgkmcnt(11)
    v_mfma_f32_16x16x32_bf16 v[128:131], v[204:207], v[144:147], v[128:131]
    ds_read_b64_tr_b16 v[192:193], v220 offset:16384
    v_mfma_f32_16x16x32_bf16 v[132:135], v[204:207], v[148:151], v[132:135]
    ds_read_b64_tr_b16 v[194:195], v220 offset:18432
    v_mfma_f32_16x16x32_bf16 v[136:139], v[204:207], v[152:155], v[136:139]
    v_add_u32 v217, s54, v209
    v_mfma_f32_16x16x32_bf16 v[140:143], v[204:207], v[156:159], v[140:143]
    s_waitcnt lgkmcnt(10)
    v_mfma_f32_16x16x32_bf16 v[16:19], v[176:179], v[160:163], v[16:19]
    ds_read_b64_tr_b16 v[196:197], v221 offset:16384
    v_mfma_f32_16x16x32_bf16 v[20:23], v[176:179], v[164:167], v[20:23]
    ds_read_b64_tr_b16 v[198:199], v221 offset:18432
    s_waitcnt lgkmcnt(11)
    v_mfma_f32_16x16x32_bf16 v[24:27], v[176:179], v[168:171], v[24:27]
    v_add_u32 v218, s54, v210
    s_waitcnt lgkmcnt(8)
    v_mfma_f32_16x16x32_bf16 v[28:31], v[176:179], v[172:175], v[28:31]
    v_mfma_f32_16x16x32_bf16 v[32:35], v[180:183], v[160:163], v[32:35]
    ds_read_b64_tr_b16 v[200:201], v222 offset:16384
    v_mfma_f32_16x16x32_bf16 v[36:39], v[180:183], v[164:167], v[36:39]
    ds_read_b64_tr_b16 v[202:203], v222 offset:18432
    v_mfma_f32_16x16x32_bf16 v[40:43], v[180:183], v[168:171], v[40:43]
    v_add_u32 v219, s54, v211
    v_mfma_f32_16x16x32_bf16 v[44:47], v[180:183], v[172:175], v[44:47]
    s_waitcnt lgkmcnt(8)
    v_mfma_f32_16x16x32_bf16 v[48:51], v[184:187], v[160:163], v[48:51]
    ds_read_b64_tr_b16 v[204:205], v223 offset:16384
    v_mfma_f32_16x16x32_bf16 v[52:55], v[184:187], v[164:167], v[52:55]
    ds_read_b64_tr_b16 v[206:207], v223 offset:18432
    v_mfma_f32_16x16x32_bf16 v[56:59], v[184:187], v[168:171], v[56:59]
    v_add_u32 v220, s54, v212
    v_mfma_f32_16x16x32_bf16 v[60:63], v[184:187], v[172:175], v[60:63]
    s_waitcnt lgkmcnt(8)
    v_mfma_f32_16x16x32_bf16 v[64:67], v[188:191], v[160:163], v[64:67]
    v_add_u32 v221, s54, v213
    v_mfma_f32_16x16x32_bf16 v[68:71], v[188:191], v[164:167], v[68:71]
    v_add_u32 v4, s55, v2
    v_mfma_f32_16x16x32_bf16 v[72:75], v[188:191], v[168:171], v[72:75]
    v_mfma_f32_16x16x32_bf16 v[76:79], v[188:191], v[172:175], v[76:79]
    s_waitcnt lgkmcnt(6)
    v_mfma_f32_16x16x32_bf16 v[80:83], v[192:195], v[160:163], v[80:83]
    v_add_u32 v222, s54, v214
    v_mfma_f32_16x16x32_bf16 v[84:87], v[192:195], v[164:167], v[84:87]
    v_add_u32 v5, s55, v3
    v_mfma_f32_16x16x32_bf16 v[88:91], v[192:195], v[168:171], v[88:91]
    v_add_u32 v223, s54, v215
    v_mfma_f32_16x16x32_bf16 v[92:95], v[192:195], v[172:175], v[92:95]
    s_waitcnt lgkmcnt(0)
    s_cmp_eq_u32 s60, 8
    s_cbranch_scc0 k1_kernel_w_hk_3
    s_waitcnt vmcnt(0)
k1_kernel_w_hk_3:
    s_cmp_le_u32 s60, 3
    s_cbranch_scc0 k1_kernel_w_hk_2
    s_cmp_eq_u32 s40, 0
    s_cbranch_scc0 k1_kernel_w_hk_2
    v_mov_b32 v10, 0
    s_cmp_eq_u32 s60, 3
    s_cbranch_scc0 k1_kernel_w_hk_1
    global_load_dword v11, v10, s[80:81] sc1
    global_load_dword v12, v10, s[80:81] offset:128 sc1
    s_branch k1_kernel_w_hk_2
k1_kernel_w_hk_1:
    s_cmp_eq_u32 s60, 2
    s_cbranch_scc0 k1_kernel_w_hk_2
    s_mov_b32 s72, 1048576
k1_kernel_w_hk_1_c:
    s_waitcnt vmcnt(0)
    v_min_u32 v11, v11, v12
    s_nop 0
    v_readfirstlane_b32 s73, v11
    s_cmp_ge_u32 s73, 114
    s_cbranch_scc1 k1_kernel_w_hk_2
    s_sub_u32 s72, s72, 1
    s_cmp_eq_u32 s72, 0
    s_cbranch_scc1 k1_kernel_w_hk_2
    s_sleep 8
    global_load_dword v11, v10, s[80:81] sc1
    global_load_dword v12, v10, s[80:81] offset:128 sc1
    s_branch k1_kernel_w_hk_1_c
k1_kernel_w_hk_2:
    s_barrier
    v_mfma_f32_16x16x32_bf16 v[96:99], v[196:199], v[160:163], v[96:99]
    ds_read_b128 v[144:147], v4 offset:0
    ds_read_b64_tr_b16 v[176:177], v216 offset:0
    v_mfma_f32_16x16x32_bf16 v[100:103], v[196:199], v[164:167], v[100:103]
    ds_read_b64_tr_b16 v[178:179], v216 offset:2048
    ds_read_b128 v[148:151], v4 offset:2048
    v_mfma_f32_16x16x32_bf16 v[104:107], v[196:199], v[168:171], v[104:107]
    ds_read_b128 v[152:155], v4 offset:4096
    ds_read_b128 v[156:159], v4 offset:6144
    v_mfma_f32_16x16x32_bf16 v[108:111], v[196:199], v[172:175], v[108:111]
    ds_read_b64_tr_b16 v[180:181], v217 offset:0
    ds_read_b64_tr_b16 v[182:183], v217 offset:2048
    v_mfma_f32_16x16x32_bf16 v[112:115], v[200:203], v[160:163], v[112:115]
    ds_read_b64_tr_b16 v[184:185], v218 offset:0
    ds_read_b64_tr_b16 v[186:187], v218 offset:2048
    v_mfma_f32_16x16x32_bf16 v[116:119], v[200:203], v[164:167], v[116:119]
    ds_read_b64_tr_b16 v[188:189], v219 offset:0
    ds_read_b64_tr_b16 v[190:191], v219 offset:2048
    v_mfma_f32_16x16x32_bf16 v[120:123], v[200:203], v[168:171], v[120:123]
    ds_read_b64_tr_b16 v[192:193], v220 offset:0
    ds_read_b64_tr_b16 v[194:195], v220 offset:2048
    v_mfma_f32_16x16x32_bf16 v[124:127], v[200:203], v[172:175], v[124:127]
    v_mfma_f32_16x16x32_bf16 v[128:131], v[204:207], v[160:163], v[128:131]
    v_mfma_f32_16x16x32_bf16 v[132:135], v[204:207], v[164:167], v[132:135]
    v_mfma_f32_16x16x32_bf16 v[136:139], v[204:207], v[168:171], v[136:139]
    v_mfma_f32_16x16x32_bf16 v[140:143], v[204:207], v[172:175], v[140:143]
    s_sub_u32 s60, s60, 1
    s_cmp_lg_u32 s60, 0
    s_cbranch_scc1 k1_kernel_w_loop
    s_waitcnt lgkmcnt(11)
    v_mfma_f32_16x16x32_bf16 v[16:19], v[176:179], v[144:147], v[16:19]
    ds_read_b64_tr_b16 v[196:197], v221 offset:0
    s_waitcnt lgkmcnt(11)
    v_mfma_f32_16x16x32_bf16 v[20:23], v[176:179], v[148:151], v[20:23]
    ds_read_b64_tr_b16 v[198:199], v221 offset:2048
    s_waitcnt lgkmcnt(11)
    v_mfma_f32_16x16x32_bf16 v[24:27], v[176:179], v[152:155], v[24:27]
    s_waitcnt lgkmcnt(10)
    v_mfma_f32_16x16x32_bf16 v[28:31], v[176:179], v[156:159], v[28:31]
    s_waitcnt lgkmcnt(8)
    v_mfma_f32_16x16x32_bf16 v[32:35], v[180:183], v[144:147], v[32:35]
    ds_read_b64_tr_b16 v[200:201], v222 offset:0
    v_mfma_f32_16x16x32_bf16 v[36:39], v[180:183], v[148:151], v[36:39]
    ds_read_b64_tr_b16 v[202:203], v222 offset:2048
    v_mfma_f32_16x16x32_bf16 v[40:43], v[180:183], v[152:155], v[40:43]
    ds_read_b128 v[160:163], v5 offset:0
    v_mfma_f32_16x16x32_bf16 v[44:47], v[180:183], v[156:159], v[44:47]
    s_waitcnt lgkmcnt(9)
    v_mfma_f32_16x16x32_bf16 v[48:51], v[184:187], v[144:147], v[48:51]
    ds_read_b64_tr_b16 v[204:205], v223 offset:0
    v_mfma_f32_16x16x32_bf16 v[52:55], v[184:187], v[148:151], v[52:55]
    ds_read_b64_tr_b16 v[206:207], v223 offset:2048
    v_mfma_f32_16x16x32_bf16 v[56:59], v[184:187], v[152:155], v[56:59]
    ds_read_b128 v[164:167], v5 offset:2048
    v_mfma_f32_16x16x32_bf16 v[60:63], v[184:187], v[156:159], v[60:63]
    s_waitcnt lgkmcnt(10)
    v_mfma_f32_16x16x32_bf16 v[64:67], v[188:191], v[144:147], v[64:67]
    ds_read_b64_tr_b16 v[176:177], v216 offset:16384
    v_mfma_f32_16x16x32_bf16 v[68:71], v[188:191], v[148:151], v[68:71]
    ds_read_b64_tr_b16 v[178:179], v216 offset:18432
    v_mfma_f32_16x16x32_bf16 v[72:75], v[188:191], v[152:155], v[72:75]
    ds_read_b128 v[168:171], v5 offset:4096
    v_mfma_f32_16x16x32_bf16 v[76:79], v[188:191], v[156:159], v[76:79]
    s_waitcnt lgkmcnt(11)
    v_mfma_f32_16x16x32_bf16 v[80:83], v[192:195], v[144:147], v[80:83]
    ds_read_b64_tr_b16 v[180:181], v217 offset:16384
    v_mfma_f32_16x16x32_bf16 v[84:87], v[192:195], v[148:151], v[84:87]
    ds_read_b64_tr_b16 v[182:183], v217 offset:18432
    v_mfma_f32_16x16x32_bf16 v[88:91], v[192:195], v[152:155], v[88:91]
    ds_read_b128 v[172:175], v5 offset:6144
    v_mfma_f32_16x16x32_bf16 v[92:95], v[192:195], v[156:159], v[92:95]
    s_waitcnt lgkmcnt(12)
    v_mfma_f32_16x16x32_bf16 v[96:99], v[196:199], v[144:147], v[96:99]
    ds_read_b64_tr_b16 v[184:185], v218 offset:16384
    v_mfma_f32_16x16x32_bf16 v[100:103], v[196:199], v[148:151], v[100:103]
    ds_read_b64_tr_b16 v[186:187], v218 offset:18432
    v_mfma_f32_16x16x32_bf16 v[104:107], v[196:199], v[152:155], v[104:107]
    v_mfma_f32_16x16x32_bf16 v[108:111], v[196:199], v[156:159], v[108:111]
    s_waitcnt lgkmcnt(12)
    v_mfma_f32_16x16x32_bf16 v[112:115], v[200:203], v[144:147], v[112:115]
    ds_read_b64_tr_b16 v[188:189], v219 offset:16384
    v_mfma_f32_16x16x32_bf16 v[116:119], v[200:203], v[148:151], v[116:119]
    ds_read_b64_tr_b16 v[190:191], v219 offset:18432
    v_mfma_f32_16x16x32_bf16 v[120:123], v[200:203], v[152:155], v[120:123]
    v_mfma_f32_16x16x32_bf16 v[124:127], v[200:203], v[156:159], v[124:127]
    s_waitcnt lgkmcnt(11)
    v_mfma_f32_16x16x32_bf16 v[128:131], v[204:207], v[144:147], v[128:131]
    ds_read_b64_tr_b16 v[192:193], v220 offset:16384
    v_mfma_f32_16x16x32_bf16 v[132:135], v[204:207], v[148:151], v[132:135]
    ds_read_b64_tr_b16 v[194:195], v220 offset:18432
    v_mfma_f32_16x16x32_bf16 v[136:139], v[204:207], v[152:155], v[136:139]
    v_mfma_f32_16x16x32_bf16 v[140:143], v[204:207], v[156:159], v[140:143]
    s_waitcnt lgkmcnt(10)
    v_mfma_f32_16x16x32_bf16 v[16:19], v[176:179], v[160:163], v[16:19]
    ds_read_b64_tr_b16 v[196:197], v221 offset:16384
    v_mfma_f32_16x16x32_bf16 v[20:23], v[176:179], v[164:167], v[20:23]
    ds_read_b64_tr_b16 v[198:199], v221 offset:18432
    s_waitcnt lgkmcnt(11)
    v_mfma_f32_16x16x32_bf16 v[24:27], v[176:179], v[168:171], v[24:27]
    s_waitcnt lgkmcnt(8)
    v_mfma_f32_16x16x32_bf16 v[28:31], v[176:179], v[172:175], v[28:31]
    v_mfma_f32_16x16x32_bf16 v[32:35], v[180:183], v[160:163], v[32:35]
    ds_read_b64_tr_b16 v[200:201], v222 offset:16384
    v_mfma_f32_16x16x32_bf16 v[36:39], v[180:183], v[164:167], v[36:39]
    ds_read_b64_tr_b16 v[202:203], v222 offset:18432
    v_mfma_f32_16x16x32_bf16 v[40:43], v[180:183], v[168:171], v[40:43]
    v_mfma_f32_16x16x32_bf16 v[44:47], v[180:183], v[172:175], v[44:47]
    s_waitcnt lgkmcnt(8)
    v_mfma_f32_16x16x32_bf16 v[48:51], v[184:187], v[160:163], v[48:51]
    ds_read_b64_tr_b16 v[204:205], v223 offset:16384
    v_mfma_f32_16x16x32_bf16 v[52:55], v[184:187], v[164:167], v[52:55]
    ds_read_b64_tr_b16 v[206:207], v223 offset:18432
    v_mfma_f32_16x16x32_bf16 v[56:59], v[184:187], v[168:171], v[56:59]
    v_mfma_f32_16x16x32_bf16 v[60:63], v[184:187], v[172:175], v[60:63]
    s_waitcnt lgkmcnt(8)
    v_mfma_f32_16x16x32_bf16 v[64:67], v[188:191], v[160:163], v[64:67]
    v_mfma_f32_16x16x32_bf16 v[68:71], v[188:191], v[164:167], v[68:71]
    v_mfma_f32_16x16x32_bf16 v[72:75], v[188:191], v[168:171], v[72:75]
    v_mfma_f32_16x16x32_bf16 v[76:79], v[188:191], v[172:175], v[76:79]
    s_waitcnt lgkmcnt(6)
    v_mfma_f32_16x16x32_bf16 v[80:83], v[192:195], v[160:163], v[80:83]
    v_mfma_f32_16x16x32_bf16 v[84:87], v[192:195], v[164:167], v[84:87]
    v_mfma_f32_16x16x32_bf16 v[88:91], v[192:195], v[168:171], v[88:91]
    v_mfma_f32_16x16x32_bf16 v[92:95], v[192:195], v[172:175], v[92:95]
    s_waitcnt lgkmcnt(4)
    v_mfma_f32_16x16x32_bf16 v[96:99], v[196:199], v[160:163], v[96:99]
    v_mfma_f32_16x16x32_bf16 v[100:103], v[196:199], v[164:167], v[100:103]
    v_mfma_f32_16x16x32_bf16 v[104:107], v[196:199], v[168:171], v[104:107]
    v_mfma_f32_16x16x32_bf16 v[108:111], v[196:199], v[172:175], v[108:111]
    s_waitcnt lgkmcnt(2)
    v_mfma_f32_16x16x32_bf16 v[112:115], v[200:203], v[160:163], v[112:115]
    v_mfma_f32_16x16x32_bf16 v[116:119], v[200:203], v[164:167], v[116:119]
    v_mfma_f32_16x16x32_bf16 v[120:123], v[200:203], v[168:171], v[120:123]
    v_mfma_f32_16x16x32_bf16 v[124:127], v[200:203], v[172:175], v[124:127]
    s_waitcnt lgkmcnt(0)
    v_mfma_f32_16x16x32_bf16 v[128:131], v[204:207], v[160:163], v[128:131]
    v_mfma_f32_16x16x32_bf16 v[132:135], v[204:207], v[164:167], v[132:135]
    v_mfma_f32_16x16x32_bf16 v[136:139], v[204:207], v[168:171], v[136:139]
    v_mfma_f32_16x16x32_bf16 v[140:143], v[204:207], v[172:175], v[140:143]
    s_barrier
    v_and_b32 v8, 15, v1
    v_lshrrev_b32 v9, 4, v1
    v_add_u32 v10, s52, v8
    v_lshlrev_b32 v11, 4, v10
    v_add_u32 v11, 147456, v11
    ds_read_b128 v[144:147], v11 offset:0
    ds_read_b128 v[148:151], v11 offset:256
    ds_read_b128 v[152:155], v11 offset:512
    ds_read_b128 v[156:159], v11 offset:768
    s_lshl_b32 s53, s51, 7
    v_mov_b32 v14, 159744
    v_cmp_eq_u32 s[58:59], 0, v9
    v_add_u32 v15, s53, v8
    v_add_u32 v15, 0, v15
    v_lshlrev_b32 v15, 4, v15
    v_add_u32 v15, 151552, v15
    v_cndmask_b32 v15, v14, v15, s[58:59]
    ds_read_b128 v[176:179], v15
    v_add_u32 v15, s53, v8
    v_add_u32 v15, 16, v15
    v_lshlrev_b32 v15, 4, v15
    v_add_u32 v15, 151552, v15
    v_cndmask_b32 v15, v14, v15, s[58:59]
    ds_read_b128 v[180:183], v15
    v_add_u32 v15, s53, v8
    v_add_u32 v15, 32, v15
    v_lshlrev_b32 v15, 4, v15
    v_add_u32 v15, 151552, v15
    v_cndmask_b32 v15, v14, v15, s[58:59]
    ds_read_b128 v[184:187], v15
    v_add_u32 v15, s53, v8
    v_add_u32 v15, 48, v15
    v_lshlrev_b32 v15, 4, v15
    v_add_u32 v15, 151552, v15
    v_cndmask_b32 v15, v14, v15, s[58:59]
    ds_read_b128 v[188:191], v15
    v_add_u32 v15, s53, v8
    v_add_u32 v15, 64, v15
    v_lshlrev_b32 v15, 4, v15
    v_add_u32 v15, 151552, v15
    v_cndmask_b32 v15, v14, v15, s[58:59]
    ds_read_b128 v[192:195], v15
    v_add_u32 v15, s53, v8
    v_add_u32 v15, 80, v15
    v_lshlrev_b32 v15, 4, v15
    v_add_u32 v15, 151552, v15
    v_cndmask_b32 v15, v14, v15, s[58:59]
    ds_read_b128 v[196:199], v15
    v_add_u32 v15, s53, v8
    v_add_u32 v15, 96, v15
    v_lshlrev_b32 v15, 4, v15
    v_add_u32 v15, 151552, v15
    v_cndmask_b32 v15, v14, v15, s[58:59]
    ds_read_b128 v[200:203], v15
    v_add_u32 v15, s53, v8
    v_add_u32 v15, 112, v15
    v_lshlrev_b32 v15, 4, v15
    v_add_u32 v15, 151552, v15
    v_cndmask_b32 v15, v14, v15, s[58:59]
    ds_read_b128 v[204:207], v15
    ds_read_b128 v[224:227], v11 offset:2048
    ds_read_b128 v[228:231], v11 offset:2304
    ds_read_b128 v[232:235], v11 offset:2560
    ds_read_b128 v[236:239], v11 offset:2816
    s_waitcnt lgkmcnt(4)
    v_mfma_f32_16x16x32_bf16 v[16:19], v[176:179], v[144:147], v[16:19]
    v_mfma_f32_16x16x32_bf16 v[20:23], v[176:179], v[148:151], v[20:23]
    v_mfma_f32_16x16x32_bf16 v[24:27], v[176:179], v[152:155], v[24:27]
    v_mfma_f32_16x16x32_bf16 v[28:31], v[176:179], v[156:159], v[28:31]
    v_mfma_f32_16x16x32_bf16 v[32:35], v[180:183], v[144:147], v[32:35]
    v_mfma_f32_16x16x32_bf16 v[36:39], v[180:183], v[148:151], v[36:39]
    v_mfma_f32_16x16x32_bf16 v[40:43], v[180:183], v[152:155], v[40:43]
    v_mfma_f32_16x16x32_bf16 v[44:47], v[180:183], v[156:159], v[44:47]
    v_mfma_f32_16x16x32_bf16 v[48:51], v[184:187], v[144:147], v[48:51]
    v_mfma_f32_16x16x32_bf16 v[52:55], v[184:187], v[148:151], v[52:55]
    v_mfma_f32_16x16x32_bf16 v[56:59], v[184:187], v[152:155], v[56:59]
    v_mfma_f32_16x16x32_bf16 v[60:63], v[184:187], v[156:159], v[60:63]
    v_mfma_f32_16x16x32_bf16 v[64:67], v[188:191], v[144:147], v[64:67]
    v_mfma_f32_16x16x32_bf16 v[68:71], v[188:191], v[148:151], v[68:71]
    v_mfma_f32_16x16x32_bf16 v[72:75], v[188:191], v[152:155], v[72:75]
    v_mfma_f32_16x16x32_bf16 v[76:79], v[188:191], v[156:159], v[76:79]
    v_mfma_f32_16x16x32_bf16 v[80:83], v[192:195], v[144:147], v[80:83]
    v_mfma_f32_16x16x32_bf16 v[84:87], v[192:195], v[148:151], v[84:87]
    v_mfma_f32_16x16x32_bf16 v[88:91], v[192:195], v[152:155], v[88:91]
    v_mfma_f32_16x16x32_bf16 v[92:95], v[192:195], v[156:159], v[92:95]
    v_mfma_f32_16x16x32_bf16 v[96:99], v[196:199], v[144:147], v[96:99]
    v_mfma_f32_16x16x32_bf16 v[100:103], v[196:199], v[148:151], v[100:103]
    v_mfma_f32_16x16x32_bf16 v[104:107], v[196:199], v[152:155], v[104:107]
    v_mfma_f32_16x16x32_bf16 v[108:111], v[196:199], v[156:159], v[108:111]
    v_mfma_f32_16x16x32_bf16 v[112:115], v[200:203], v[144:147], v[112:115]
    v_mfma_f32_16x16x32_bf16 v[116:119], v[200:203], v[148:151], v[116:119]
    v_mfma_f32_16x16x32_bf16 v[120:123], v[200:203], v[152:155], v[120:123]
    v_mfma_f32_16x16x32_bf16 v[124:127], v[200:203], v[156:159], v[124:127]
    v_mfma_f32_16x16x32_bf16 v[128:131], v[204:207], v[144:147], v[128:131]
    v_mfma_f32_16x16x32_bf16 v[132:135], v[204:207], v[148:151], v[132:135]
    v_mfma_f32_16x16x32_bf16 v[136:139], v[204:207], v[152:155], v[136:139]
    v_mfma_f32_16x16x32_bf16 v[140:143], v[204:207], v[156:159], v[140:143]
    s_waitcnt lgkmcnt(0)
    s_lshl_b32 s53, s40, 14
    v_lshlrev_b32 v13, 4, v1
    v_add_u32 v13, s53, v13
    s_nop 4
    ds_write_b128 v13, v[24:27] offset:0
    ds_write_b128 v13, v[40:43] offset:1024
    ds_write_b128 v13, v[56:59] offset:2048
    ds_write_b128 v13, v[72:75] offset:3072
    ds_write_b128 v13, v[88:91] offset:4096
    ds_write_b128 v13, v[104:107] offset:5120
    ds_write_b128 v13, v[120:123] offset:6144
    ds_write_b128 v13, v[136:139] offset:7168
    ds_write_b128 v13, v[28:31] offset:8192
    ds_write_b128 v13, v[44:47] offset:9216
    ds_write_b128 v13, v[60:63] offset:10240
    ds_write_b128 v13, v[76:79] offset:11264
    ds_write_b128 v13, v[92:95] offset:12288
    ds_write_b128 v13, v[108:111] offset:13312
    ds_write_b128 v13, v[124:127] offset:14336
    ds_write_b128 v13, v[140:143] offset:15360
    s_mul_i32 s53, s40, 17408
    s_add_u32 s53, s53, 65536
    v_mul_u32_u24 v10, 272, v8
    v_lshl_add_u32 v10, v9, 3, v10
    v_add_u32 v10, s53, v10
    v_lshrrev_b32 v11, 4, v1
    v_mul_u32_u24 v11, 272, v11
    v_lshl_add_u32 v11, v8, 4, v11
    v_add_u32 v11, s53, v11
    s_add_u32 s53, s48, s52
    v_add_u32 v12, s53, v9
    s_movk_i32 s54, 4736
    v_mul_lo_u32 v12, v12, s54
    s_lshl_b32 s54, s45, 9
    s_lshl_b32 s55, s51, 8
    s_add_u32 s54, s54, s55
    v_lshl_add_u32 v13, v8, 4, s54
    v_add_u32 v12, v12, v13
    v_lshrrev_b32 v13, 3, v8
    s_lshl_b32 s54, s45, 2
    s_lshl_b32 s55, s51, 1
    s_add_u32 s54, s54, s55
    v_add_u32 v13, s54, v13
    v_mov_b32 v14, 2146435072
    v_cmp_gt_u32 vcc, 27, v13
    s_nop 1
    v_cndmask_b32 v12, v14, v12, vcc
    s_waitcnt lgkmcnt(0)
    s_barrier
    v_pk_mul_f32 v[144:145], v[16:17], v[16:17]
    v_pk_mul_f32 v[146:147], v[18:19], v[18:19]
    v_pk_mul_f32 v[148:149], v[32:33], v[32:33]
    v_pk_mul_f32 v[150:151], v[34:35], v[34:35]
    v_pk_mul_f32 v[152:153], v[48:49], v[48:49]
    v_pk_mul_f32 v[154:155], v[50:51], v[50:51]
    v_pk_mul_f32 v[156:157], v[64:65], v[64:65]
    v_pk_mul_f32 v[158:159], v[66:67], v[66:67]
    v_pk_mul_f32 v[160:161], v[80:81], v[80:81]
    v_pk_mul_f32 v[162:163], v[82:83], v[82:83]
    v_pk_mul_f32 v[164:165], v[96:97], v[96:97]
    v_pk_mul_f32 v[166:167], v[98:99], v[98:99]
    v_pk_mul_f32 v[168:169], v[112:113], v[112:113]
    v_pk_mul_f32 v[170:171], v[114:115], v[114:115]
    v_pk_mul_f32 v[172:173], v[128:129], v[128:129]
    v_pk_mul_f32 v[174:175], v[130:131], v[130:131]
    v_pk_fma_f32 v[144:145], v[144:145], v[226:227], v[226:227] op_sel:[0,1,0] op_sel_hi:[1,1,0]
    v_pk_fma_f32 v[146:147], v[146:147], v[226:227], v[226:227] op_sel:[0,1,0] op_sel_hi:[1,1,0]
    v_pk_fma_f32 v[148:149], v[148:149], v[226:227], v[226:227] op_sel:[0,1,0] op_sel_hi:[1,1,0]
    v_pk_fma_f32 v[150:151], v[150:151], v[226:227], v[226:227] op_sel:[0,1,0] op_sel_hi:[1,1,0]
    v_pk_fma_f32 v[152:153], v[152:153], v[226:227], v[226:227] op_sel:[0,1,0] op_sel_hi:[1,1,0]
    v_pk_fma_f32 v[154:155], v[154:155], v[226:227], v[226:227] op_sel:[0,1,0] op_sel_hi:[1,1,0]
    v_pk_fma_f32 v[156:157], v[156:157], v[226:227], v[226:227] op_sel:[0,1,0] op_sel_hi:[1,1,0]
    v_pk_fma_f32 v[158:159], v[158:159], v[226:227], v[226:227] op_sel:[0,1,0] op_sel_hi:[1,1,0]
    v_pk_fma_f32 v[160:161], v[160:161], v[226:227], v[226:227] op_sel:[0,1,0] op_sel_hi:[1,1,0]
    v_pk_fma_f32 v[162:163], v[162:163], v[226:227], v[226:227] op_sel:[0,1,0] op_sel_hi:[1,1,0]
    v_pk_fma_f32 v[164:165], v[164:165], v[226:227], v[226:227] op_sel:[0,1,0] op_sel_hi:[1,1,0]
    v_pk_fma_f32 v[166:167], v[166:167], v[226:227], v[226:227] op_sel:[0,1,0] op_sel_hi:[1,1,0]
    v_pk_fma_f32 v[168:169], v[168:169], v[226:227], v[226:227] op_sel:[0,1,0] op_sel_hi:[1,1,0]
    v_pk_fma_f32 v[170:171], v[170:171], v[226:227], v[226:227] op_sel:[0,1,0] op_sel_hi:[1,1,0]
    v_pk_fma_f32 v[172:173], v[172:173], v[226:227], v[226:227] op_sel:[0,1,0] op_sel_hi:[1,1,0]
    v_pk_fma_f32 v[174:175], v[174:175], v[226:227], v[226:227] op_sel:[0,1,0] op_sel_hi:[1,1,0]
    v_pk_mul_f32 v[144:145], v[144:145], v[16:17]
    v_pk_mul_f32 v[146:147], v[146:147], v[18:19]
    v_pk_mul_f32 v[148:149], v[148:149], v[32:33]
    v_pk_mul_f32 v[150:151], v[150:151], v[34:35]
    v_pk_mul_f32 v[152:153], v[152:153], v[48:49]
    v_pk_mul_f32 v[154:155], v[154:155], v[50:51]
    v_pk_mul_f32 v[156:157], v[156:157], v[64:65]
    v_pk_mul_f32 v[158:159], v[158:159], v[66:67]
    v_pk_mul_f32 v[160:161], v[160:161], v[80:81]
    v_pk_mul_f32 v[162:163], v[162:163], v[82:83]
    v_pk_mul_f32 v[164:165], v[164:165], v[96:97]
    v_pk_mul_f32 v[166:167], v[166:167], v[98:99]
    v_pk_mul_f32 v[168:169], v[168:169], v[112:113]
    v_pk_mul_f32 v[170:171], v[170:171], v[114:115]
    v_pk_mul_f32 v[172:173], v[172:173], v[128:129]
    v_pk_mul_f32 v[174:175], v[174:175], v[130:131]
    v_exp_f32 v144, v144
    v_exp_f32 v145, v145
    v_exp_f32 v146, v146
    v_exp_f32 v147, v147
    v_exp_f32 v148, v148
    v_exp_f32 v149, v149
    v_exp_f32 v150, v150
    v_exp_f32 v151, v151
    v_exp_f32 v152, v152
    v_exp_f32 v153, v153
    v_exp_f32 v154, v154
    v_exp_f32 v155, v155
    v_exp_f32 v156, v156
    v_exp_f32 v157, v157
    v_exp_f32 v158, v158
    v_exp_f32 v159, v159
    v_exp_f32 v160, v160
    v_exp_f32 v161, v161
    v_exp_f32 v162, v162
    v_exp_f32 v163, v163
    v_exp_f32 v164, v164
    v_exp_f32 v165, v165
    v_exp_f32 v166, v166
    v_exp_f32 v167, v167
    v_exp_f32 v168, v168
    v_exp_f32 v169, v169
    v_exp_f32 v170, v170
    v_exp_f32 v171, v171
    v_exp_f32 v172, v172
    v_exp_f32 v173, v173
    v_exp_f32 v174, v174
    v_exp_f32 v175, v175
    v_pk_fma_f32 v[144:145], v[144:145], v[224:225], v[224:225] op_sel:[0,1,1] op_sel_hi:[1,1,1]
    v_pk_fma_f32 v[146:147], v[146:147], v[224:225], v[224:225] op_sel:[0,1,1] op_sel_hi:[1,1,1]
    v_pk_fma_f32 v[148:149], v[148:149], v[224:225], v[224:225] op_sel:[0,1,1] op_sel_hi:[1,1,1]
    v_pk_fma_f32 v[150:151], v[150:151], v[224:225], v[224:225] op_sel:[0,1,1] op_sel_hi:[1,1,1]
    v_pk_fma_f32 v[152:153], v[152:153], v[224:225], v[224:225] op_sel:[0,1,1] op_sel_hi:[1,1,1]
    v_pk_fma_f32 v[154:155], v[154:155], v[224:225], v[224:225] op_sel:[0,1,1] op_sel_hi:[1,1,1]
    v_pk_fma_f32 v[156:157], v[156:157], v[224:225], v[224:225] op_sel:[0,1,1] op_sel_hi:[1,1,1]
    v_pk_fma_f32 v[158:159], v[158:159], v[224:225], v[224:225] op_sel:[0,1,1] op_sel_hi:[1,1,1]
    v_pk_fma_f32 v[160:161], v[160:161], v[224:225], v[224:225] op_sel:[0,1,1] op_sel_hi:[1,1,1]
    v_pk_fma_f32 v[162:163], v[162:163], v[224:225], v[224:225] op_sel:[0,1,1] op_sel_hi:[1,1,1]
    v_pk_fma_f32 v[164:165], v[164:165], v[224:225], v[224:225] op_sel:[0,1,1] op_sel_hi:[1,1,1]
    v_pk_fma_f32 v[166:167], v[166:167], v[224:225], v[224:225] op_sel:[0,1,1] op_sel_hi:[1,1,1]
    v_pk_fma_f32 v[168:169], v[168:169], v[224:225], v[224:225] op_sel:[0,1,1] op_sel_hi:[1,1,1]
    v_pk_fma_f32 v[170:171], v[170:171], v[224:225], v[224:225] op_sel:[0,1,1] op_sel_hi:[1,1,1]
    v_pk_fma_f32 v[172:173], v[172:173], v[224:225], v[224:225] op_sel:[0,1,1] op_sel_hi:[1,1,1]
    v_pk_fma_f32 v[174:175], v[174:175], v[224:225], v[224:225] op_sel:[0,1,1] op_sel_hi:[1,1,1]
    v_rcp_f32 v144, v144
    v_rcp_f32 v145, v145
    v_rcp_f32 v146, v146
    v_rcp_f32 v147, v147
    v_rcp_f32 v148, v148
    v_rcp_f32 v149, v149
    v_rcp_f32 v150, v150
    v_rcp_f32 v151, v151
    v_rcp_f32 v152, v152
    v_rcp_f32 v153, v153
    v_rcp_f32 v154, v154
    v_rcp_f32 v155, v155
    v_rcp_f32 v156, v156
    v_rcp_f32 v157, v157
    v_rcp_f32 v158, v158
    v_rcp_f32 v159, v159
    v_rcp_f32 v160, v160
    v_rcp_f32 v161, v161
    v_rcp_f32 v162, v162
    v_rcp_f32 v163, v163
    v_rcp_f32 v164, v164
    v_rcp_f32 v165, v165
    v_rcp_f32 v166, v166
    v_rcp_f32 v167, v167
    v_rcp_f32 v168, v168
    v_rcp_f32 v169, v169
    v_rcp_f32 v170, v170
    v_rcp_f32 v171, v171
    v_rcp_f32 v172, v172
    v_rcp_f32 v173, v173
    v_rcp_f32 v174, v174
    v_rcp_f32 v175, v175
    v_pk_mul_f32 v[144:145], v[144:145], v[16:17]
    v_pk_mul_f32 v[146:147], v[146:147], v[18:19]
    v_pk_mul_f32 v[148:149], v[148:149], v[32:33]
    v_pk_mul_f32 v[150:151], v[150:151], v[34:35]
    v_pk_mul_f32 v[152:153], v[152:153], v[48:49]
    v_pk_mul_f32 v[154:155], v[154:155], v[50:51]
    v_pk_mul_f32 v[156:157], v[156:157], v[64:65]
    v_pk_mul_f32 v[158:159], v[158:159], v[66:67]
    v_pk_mul_f32 v[160:161], v[160:161], v[80:81]
    v_pk_mul_f32 v[162:163], v[162:163], v[82:83]
    v_pk_mul_f32 v[164:165], v[164:165], v[96:97]
    v_pk_mul_f32 v[166:167], v[166:167], v[98:99]
    v_pk_mul_f32 v[168:169], v[168:169], v[112:113]
    v_pk_mul_f32 v[170:171], v[170:171], v[114:115]
    v_pk_mul_f32 v[172:173], v[172:173], v[128:129]
    v_pk_mul_f32 v[174:175], v[174:175], v[130:131]
    v_cvt_pk_bf16_f32 v176, v144, v145
    v_cvt_pk_bf16_f32 v177, v146, v147
    v_cvt_pk_bf16_f32 v178, v148, v149
    v_cvt_pk_bf16_f32 v179, v150, v151
    v_cvt_pk_bf16_f32 v180, v152, v153
    v_cvt_pk_bf16_f32 v181, v154, v155
    v_cvt_pk_bf16_f32 v182, v156, v157
    v_cvt_pk_bf16_f32 v183, v158, v159
    v_cvt_pk_bf16_f32 v184, v160, v161
    v_cvt_pk_bf16_f32 v185, v162, v163
    v_cvt_pk_bf16_f32 v186, v164, v165
    v_cvt_pk_bf16_f32 v187, v166, v167
    v_cvt_pk_bf16_f32 v188, v168, v169
    v_cvt_pk_bf16_f32 v189, v170, v171
    v_cvt_pk_bf16_f32 v190, v172, v173
    v_cvt_pk_bf16_f32 v191, v174, v175
    ds_write_b64 v10, v[176:177] offset:0
    ds_write_b64 v10, v[178:179] offset:32
    ds_write_b64 v10, v[180:181] offset:64
    ds_write_b64 v10, v[182:183] offset:96
    ds_write_b64 v10, v[184:185] offset:128
    ds_write_b64 v10, v[186:187] offset:160
    ds_write_b64 v10, v[188:189] offset:192
    ds_write_b64 v10, v[190:191] offset:224
    s_waitcnt lgkmcnt(0)
    ds_read_b128 v[192:195], v11 offset:0
    ds_read_b128 v[196:199], v11 offset:1088
    ds_read_b128 v[200:203], v11 offset:2176
    ds_read_b128 v[204:207], v11 offset:3264
    s_mov_b32 s53, 0
    s_waitcnt lgkmcnt(3)
    buffer_store_dwordx4 v[192:195], v12, s[24:27], s53 offen sc1
    s_add_u32 s53, s53, 18944
    s_waitcnt lgkmcnt(2)
    buffer_store_dwordx4 v[196:199], v12, s[24:27], s53 offen sc1
    s_add_u32 s53, s53, 18944
    s_waitcnt lgkmcnt(1)
    buffer_store_dwordx4 v[200:203], v12, s[24:27], s53 offen sc1
    s_add_u32 s53, s53, 18944
    s_waitcnt lgkmcnt(0)
    buffer_store_dwordx4 v[204:207], v12, s[24:27], s53 offen sc1
    v_pk_mul_f32 v[144:145], v[20:21], v[20:21]
    v_pk_mul_f32 v[146:147], v[22:23], v[22:23]
    v_pk_mul_f32 v[148:149], v[36:37], v[36:37]
    v_pk_mul_f32 v[150:151], v[38:39], v[38:39]
    v_pk_mul_f32 v[152:153], v[52:53], v[52:53]
    v_pk_mul_f32 v[154:155], v[54:55], v[54:55]
    v_pk_mul_f32 v[156:157], v[68:69], v[68:69]
    v_pk_mul_f32 v[158:159], v[70:71], v[70:71]
    v_pk_mul_f32 v[160:161], v[84:85], v[84:85]
    v_pk_mul_f32 v[162:163], v[86:87], v[86:87]
    v_pk_mul_f32 v[164:165], v[100:101], v[100:101]
    v_pk_mul_f32 v[166:167], v[102:103], v[102:103]
    v_pk_mul_f32 v[168:169], v[116:117], v[116:117]
    v_pk_mul_f32 v[170:171], v[118:119], v[118:119]
    v_pk_mul_f32 v[172:173], v[132:133], v[132:133]
    v_pk_mul_f32 v[174:175], v[134:135], v[134:135]
    v_pk_fma_f32 v[144:145], v[144:145], v[230:231], v[230:231] op_sel:[0,1,0] op_sel_hi:[1,1,0]
    v_pk_fma_f32 v[146:147], v[146:147], v[230:231], v[230:231] op_sel:[0,1,0] op_sel_hi:[1,1,0]
    v_pk_fma_f32 v[148:149], v[148:149], v[230:231], v[230:231] op_sel:[0,1,0] op_sel_hi:[1,1,0]
    v_pk_fma_f32 v[150:151], v[150:151], v[230:231], v[230:231] op_sel:[0,1,0] op_sel_hi:[1,1,0]
    v_pk_fma_f32 v[152:153], v[152:153], v[230:231], v[230:231] op_sel:[0,1,0] op_sel_hi:[1,1,0]
    v_pk_fma_f32 v[154:155], v[154:155], v[230:231], v[230:231] op_sel:[0,1,0] op_sel_hi:[1,1,0]
    v_pk_fma_f32 v[156:157], v[156:157], v[230:231], v[230:231] op_sel:[0,1,0] op_sel_hi:[1,1,0]
    v_pk_fma_f32 v[158:159], v[158:159], v[230:231], v[230:231] op_sel:[0,1,0] op_sel_hi:[1,1,0]
    v_pk_fma_f32 v[160:161], v[160:161], v[230:231], v[230:231] op_sel:[0,1,0] op_sel_hi:[1,1,0]
    v_pk_fma_f32 v[162:163], v[162:163], v[230:231], v[230:231] op_sel:[0,1,0] op_sel_hi:[1,1,0]
    v_pk_fma_f32 v[164:165], v[164:165], v[230:231], v[230:231] op_sel:[0,1,0] op_sel_hi:[1,1,0]
    v_pk_fma_f32 v[166:167], v[166:167], v[230:231], v[230:231] op_sel:[0,1,0] op_sel_hi:[1,1,0]
    v_pk_fma_f32 v[168:169], v[168:169], v[230:231], v[230:231] op_sel:[0,1,0] op_sel_hi:[1,1,0]
    v_pk_fma_f32 v[170:171], v[170:171], v[230:231], v[230:231] op_sel:[0,1,0] op_sel_hi:[1,1,0]
    v_pk_fma_f32 v[172:173], v[172:173], v[230:231], v[230:231] op_sel:[0,1,0] op_sel_hi:[1,1,0]
    v_pk_fma_f32 v[174:175], v[174:175], v[230:231], v[230:231] op_sel:[0,1,0] op_sel_hi:[1,1,0]
    v_pk_mul_f32 v[144:145], v[144:145], v[20:21]
    v_pk_mul_f32 v[146:147], v[146:147], v[22:23]
    v_pk_mul_f32 v[148:149], v[148:149], v[36:37]
    v_pk_mul_f32 v[150:151], v[150:151], v[38:39]
    v_pk_mul_f32 v[152:153], v[152:153], v[52:53]
    v_pk_mul_f32 v[154:155], v[154:155], v[54:55]
    v_pk_mul_f32 v[156:157], v[156:157], v[68:69]
    v_pk_mul_f32 v[158:159], v[158:159], v[70:71]
    v_pk_mul_f32 v[160:161], v[160:161], v[84:85]
    v_pk_mul_f32 v[162:163], v[162:163], v[86:87]
    v_pk_mul_f32 v[164:165], v[164:165], v[100:101]
    v_pk_mul_f32 v[166:167], v[166:167], v[102:103]
    v_pk_mul_f32 v[168:169], v[168:169], v[116:117]
    v_pk_mul_f32 v[170:171], v[170:171], v[118:119]
    v_pk_mul_f32 v[172:173], v[172:173], v[132:133]
    v_pk_mul_f32 v[174:175], v[174:175], v[134:135]
    v_exp_f32 v144, v144
    v_exp_f32 v145, v145
    v_exp_f32 v146, v146
    v_exp_f32 v147, v147
    v_exp_f32 v148, v148
    v_exp_f32 v149, v149
    v_exp_f32 v150, v150
    v_exp_f32 v151, v151
    v_exp_f32 v152, v152
    v_exp_f32 v153, v153
    v_exp_f32 v154, v154
    v_exp_f32 v155, v155
    v_exp_f32 v156, v156
    v_exp_f32 v157, v157
    v_exp_f32 v158, v158
    v_exp_f32 v159, v159
    v_exp_f32 v160, v160
    v_exp_f32 v161, v161
    v_exp_f32 v162, v162
    v_exp_f32 v163, v163
    v_exp_f32 v164, v164
    v_exp_f32 v165, v165
    v_exp_f32 v166, v166
    v_exp_f32 v167, v167
    v_exp_f32 v168, v168
    v_exp_f32 v169, v169
    v_exp_f32 v170, v170
    v_exp_f32 v171, v171
    v_exp_f32 v172, v172
    v_exp_f32 v173, v173
    v_exp_f32 v174, v174
    v_exp_f32 v175, v175
    v_pk_fma_f32 v[144:145], v[144:145], v[228:229], v[228:229] op_sel:[0,1,1] op_sel_hi:[1,1,1]
    v_pk_fma_f32 v[146:147], v[146:147], v[228:229], v[228:229] op_sel:[0,1,1] op_sel_hi:[1,1,1]
    v_pk_fma_f32 v[148:149], v[148:149], v[228:229], v[228:229] op_sel:[0,1,1] op_sel_hi:[1,1,1]
    v_pk_fma_f32 v[150:151], v[150:151], v[228:229], v[228:229] op_sel:[0,1,1] op_sel_hi:[1,1,1]
    v_pk_fma_f32 v[152:153], v[152:153], v[228:229], v[228:229] op_sel:[0,1,1] op_sel_hi:[1,1,1]
    v_pk_fma_f32 v[154:155], v[154:155], v[228:229], v[228:229] op_sel:[0,1,1] op_sel_hi:[1,1,1]
    v_pk_fma_f32 v[156:157], v[156:157], v[228:229], v[228:229] op_sel:[0,1,1] op_sel_hi:[1,1,1]
    v_pk_fma_f32 v[158:159], v[158:159], v[228:229], v[228:229] op_sel:[0,1,1] op_sel_hi:[1,1,1]
    v_pk_fma_f32 v[160:161], v[160:161], v[228:229], v[228:229] op_sel:[0,1,1] op_sel_hi:[1,1,1]
    v_pk_fma_f32 v[162:163], v[162:163], v[228:229], v[228:229] op_sel:[0,1,1] op_sel_hi:[1,1,1]
    v_pk_fma_f32 v[164:165], v[164:165], v[228:229], v[228:229] op_sel:[0,1,1] op_sel_hi:[1,1,1]
    v_pk_fma_f32 v[166:167], v[166:167], v[228:229], v[228:229] op_sel:[0,1,1] op_sel_hi:[1,1,1]
    v_pk_fma_f32 v[168:169], v[168:169], v[228:229], v[228:229] op_sel:[0,1,1] op_sel_hi:[1,1,1]
    v_pk_fma_f32 v[170:171], v[170:171], v[228:229], v[228:229] op_sel:[0,1,1] op_sel_hi:[1,1,1]
    v_pk_fma_f32 v[172:173], v[172:173], v[228:229], v[228:229] op_sel:[0,1,1] op_sel_hi:[1,1,1]
    v_pk_fma_f32 v[174:175], v[174:175], v[228:229], v[228:229] op_sel:[0,1,1] op_sel_hi:[1,1,1]
    v_rcp_f32 v144, v144
    v_rcp_f32 v145, v145
    v_rcp_f32 v146, v146
    v_rcp_f32 v147, v147
    v_rcp_f32 v148, v148
    v_rcp_f32 v149, v149
    v_rcp_f32 v150, v150
    v_rcp_f32 v151, v151
    v_rcp_f32 v152, v152
    v_rcp_f32 v153, v153
    v_rcp_f32 v154, v154
    v_rcp_f32 v155, v155
    v_rcp_f32 v156, v156
    v_rcp_f32 v157, v157
    v_rcp_f32 v158, v158
    v_rcp_f32 v159, v159
    v_rcp_f32 v160, v160
    v_rcp_f32 v161, v161
    v_rcp_f32 v162, v162
    v_rcp_f32 v163, v163
    v_rcp_f32 v164, v164
    v_rcp_f32 v165, v165
    v_rcp_f32 v166, v166
    v_rcp_f32 v167, v167
    v_rcp_f32 v168, v168
    v_rcp_f32 v169, v169
    v_rcp_f32 v170, v170
    v_rcp_f32 v171, v171
    v_rcp_f32 v172, v172
    v_rcp_f32 v173, v173
    v_rcp_f32 v174, v174
    v_rcp_f32 v175, v175
    v_pk_mul_f32 v[144:145], v[144:145], v[20:21]
    v_pk_mul_f32 v[146:147], v[146:147], v[22:23]
    v_pk_mul_f32 v[148:149], v[148:149], v[36:37]
    v_pk_mul_f32 v[150:151], v[150:151], v[38:39]
    v_pk_mul_f32 v[152:153], v[152:153], v[52:53]
    v_pk_mul_f32 v[154:155], v[154:155], v[54:55]
    v_pk_mul_f32 v[156:157], v[156:157], v[68:69]
    v_pk_mul_f32 v[158:159], v[158:159], v[70:71]
    v_pk_mul_f32 v[160:161], v[160:161], v[84:85]
    v_pk_mul_f32 v[162:163], v[162:163], v[86:87]
    v_pk_mul_f32 v[164:165], v[164:165], v[100:101]
    v_pk_mul_f32 v[166:167], v[166:167], v[102:103]
    v_pk_mul_f32 v[168:169], v[168:169], v[116:117]
    v_pk_mul_f32 v[170:171], v[170:171], v[118:119]
    v_pk_mul_f32 v[172:173], v[172:173], v[132:133]
    v_pk_mul_f32 v[174:175], v[174:175], v[134:135]
    v_cvt_pk_bf16_f32 v176, v144, v145
    v_cvt_pk_bf16_f32 v177, v146, v147
    v_cvt_pk_bf16_f32 v178, v148, v149
    v_cvt_pk_bf16_f32 v179, v150, v151
    v_cvt_pk_bf16_f32 v180, v152, v153
    v_cvt_pk_bf16_f32 v181, v154, v155
    v_cvt_pk_bf16_f32 v182, v156, v157
    v_cvt_pk_bf16_f32 v183, v158, v159
    v_cvt_pk_bf16_f32 v184, v160, v161
    v_cvt_pk_bf16_f32 v185, v162, v163
    v_cvt_pk_bf16_f32 v186, v164, v165
    v_cvt_pk_bf16_f32 v187, v166, v167
    v_cvt_pk_bf16_f32 v188, v168, v169
    v_cvt_pk_bf16_f32 v189, v170, v171
    v_cvt_pk_bf16_f32 v190, v172, v173
    v_cvt_pk_bf16_f32 v191, v174, v175
    ds_write_b64 v10, v[176:177] offset:4352
    ds_write_b64 v10, v[178:179] offset:4384
    ds_write_b64 v10, v[180:181] offset:4416
    ds_write_b64 v10, v[182:183] offset:4448
    ds_write_b64 v10, v[184:185] offset:4480
    ds_write_b64 v10, v[186:187] offset:4512
    ds_write_b64 v10, v[188:189] offset:4544
    ds_write_b64 v10, v[190:191] offset:4576
    s_waitcnt lgkmcnt(0)
    ds_read_b128 v[192:195], v11 offset:4352
    ds_read_b128 v[196:199], v11 offset:5440
    ds_read_b128 v[200:203], v11 offset:6528
    ds_read_b128 v[204:207], v11 offset:7616
    s_mov_b32 s53, 75776
    s_waitcnt lgkmcnt(3)
    buffer_store_dwordx4 v[192:195], v12, s[24:27], s53 offen sc1
    s_add_u32 s53, s53, 18944
    s_waitcnt lgkmcnt(2)
    buffer_store_dwordx4 v[196:199], v12, s[24:27], s53 offen sc1
    s_add_u32 s53, s53, 18944
    s_waitcnt lgkmcnt(1)
    buffer_store_dwordx4 v[200:203], v12, s[24:27], s53 offen sc1
    s_add_u32 s53, s53, 18944
    s_waitcnt lgkmcnt(0)
    buffer_store_dwordx4 v[204:207], v12, s[24:27], s53 offen sc1
    s_waitcnt vmcnt(0)
    s_endpgm
k1_kernel_cq:
    s_cmp_eq_u32 s40, 3
    s_cbranch_scc0 k1_kernel_q_nocp
    s_getpc_b64 s[68:69]
k1_kernel_pcq:
    s_sub_u32 s68, s68, k1_kernel_pcq-k1_kernel
    s_subb_u32 s69, s69, 0
    s_lshr_b32 s70, s2, 3
    s_lshl_b32 s70, s70, 4
    v_add_u32 v240, s70, v1
    v_lshlrev_b32 v240, 7, v240
    s_mov_b32 s70, code_end-k1_kernel-4
    v_min_u32 v240, s70, v240
    v_mov_b32 v241, s69
    v_add_co_u32 v240, vcc, s68, v240
    v_addc_co_u32 v241, vcc, 0, v241, vcc
    s_mov_b64 exec, 0xffff
    global_load_dword v242, v[240:241], off
    s_mov_b64 exec, -1
k1_kernel_q_nocp:
    s_waitcnt lgkmcnt(0)
    s_mov_b32 s16, s4
    s_mov_b32 s17, s5
    s_mov_b32 s18, 2621440
    s_mov_b32 s19, 0x20000
    s_cmp_eq_u32 s44, 0
    s_cselect_b32 s20, s6, s12
    s_cselect_b32 s21, s7, s13
    s_mov_b32 s22, 2457600
    s_cselect_b32 s22, s22, 2211840
    s_mov_b32 s23, 0x20000
    s_mov_b32 s24, s10
    s_mov_b32 s25, s11
    s_mov_b32 s26, 33554432
    s_mov_b32 s27, 0x20000
    s_mov_b32 s28, s8
    s_mov_b32 s29, s9
    s_mov_b32 s30, 25600
    s_mov_b32 s31, 0x20000
    s_mov_b32 s32, s14
    s_mov_b32 s33, s15
    s_mov_b32 s34, 3456
    s_mov_b32 s35, 0x20000
    s_lshr_b32 s50, s40, 1
    s_and_b32 s51, s40, 1
    s_lshl_b32 s52, s50, 6
    v_and_b32 v8, 15, v1
    v_lshrrev_b32 v9, 4, v1
    v_lshrrev_b32 v10, 1, v8
    v_xor_b32 v10, v10, v9
    v_lshlrev_b32 v10, 4, v10
    v_add_u32 v11, s52, v8
    v_lshl_add_u32 v2, v11, 7, v10
    v_add_u32 v2, 98304, v2
    v_xor_b32 v3, 64, v2
    v_bfe_u32 v10, v1, 2, 2
    v_and_b32 v11, 3, v1
    v_and_b32 v12, 1, v9
    v_lshl_add_u32 v12, v12, 2, v10
    v_lshlrev_b32 v12, 2, v12
    v_lshl_add_u32 v13, v9, 3, v10
    v_lshlrev_b32 v13, 9, v13
    v_mul_u32_u24 v14, 5, v11
    s_mul_i32 s53, s51, 20
    v_add_u32 v15, s53, v14
    v_add_u32 v15, 0, v15
    v_xor_b32 v15, v15, v12
    v_lshl_add_u32 v208, v15, 3, v13
    v_add_u32 v15, s53, v14
    v_add_u32 v15, 1, v15
    v_xor_b32 v15, v15, v12
    v_lshl_add_u32 v209, v15, 3, v13
    v_add_u32 v15, s53, v14
    v_add_u32 v15, 2, v15
    v_xor_b32 v15, v15, v12
    v_lshl_add_u32 v210, v15, 3, v13
    v_add_u32 v15, s53, v14
    v_add_u32 v15, 3, v15
    v_xor_b32 v15, v15, v12
    v_lshl_add_u32 v211, v15, 3, v13
    v_add_u32 v15, s53, v14
    v_add_u32 v15, 4, v15
    v_xor_b32 v15, v15, v12
    v_lshl_add_u32 v212, v15, 3, v13
    s_mul_i32 s54, s51, 3
    s_add_u32 s54, s54, 40
    v_add_u32 v15, s54, v14
    v_xor_b32 v15, v15, v12
    v_lshl_add_u32 v213, v15, 3, v13
    s_mul_i32 s54, s51, 3
    s_add_u32 s54, s54, 41
    v_add_u32 v15, s54, v14
    v_xor_b32 v15, v15, v12
    v_lshl_add_u32 v214, v15, 3, v13
    v_add_u32 v15, 42, v14
    v_xor_b32 v15, v15, v12
    v_lshl_add_u32 v215, v15, 3, v13
    v_mov_b32 v16, 0
    v_mov_b32 v17, 0
    v_mov_b32 v18, 0
    v_mov_b32 v19, 0
    v_mov_b32 v20, 0
    v_mov_b32 v21, 0
    v_mov_b32 v22, 0
    v_mov_b32 v23, 0
    v_mov_b32 v24, 0
    v_mov_b32 v25, 0
    v_mov_b32 v26, 0
    v_mov_b32 v27, 0
    v_mov_b32 v28, 0
    v_mov_b32 v29, 0
    v_mov_b32 v30, 0
    v_mov_b32 v31, 0
    v_mov_b32 v32, 0
    v_mov_b32 v33, 0
    v_mov_b32 v34, 0
    v_mov_b32 v35, 0
    v_mov_b32 v36, 0
    v_mov_b32 v37, 0
    v_mov_b32 v38, 0
    v_mov_b32 v39, 0
    v_mov_b32 v40, 0
    v_mov_b32 v41, 0
    v_mov_b32 v42, 0
    v_mov_b32 v43, 0
    v_mov_b32 v44, 0
    v_mov_b32 v45, 0
    v_mov_b32 v46, 0
    v_mov_b32 v47, 0
    v_mov_b32 v48, 0
    v_mov_b32 v49, 0
    v_mov_b32 v50, 0
    v_mov_b32 v51, 0
    v_mov_b32 v52, 0
    v_mov_b32 v53, 0
    v_mov_b32 v54, 0
    v_mov_b32 v55, 0
    v_mov_b32 v56, 0
    v_mov_b32 v57, 0
    v_mov_b32 v58, 0
    v_mov_b32 v59, 0
    v_mov_b32 v60, 0
    v_mov_b32 v61, 0
    v_mov_b32 v62, 0
    v_mov_b32 v63, 0
    v_mov_b32 v64, 0
    v_mov_b32 v65, 0
    v_mov_b32 v66, 0
    v_mov_b32 v67, 0
    v_mov_b32 v68, 0
    v_mov_b32 v69, 0
    v_mov_b32 v70, 0
    v_mov_b32 v71, 0
    v_mov_b32 v72, 0
    v_mov_b32 v73, 0
    v_mov_b32 v74, 0
    v_mov_b32 v75, 0
    v_mov_b32 v76, 0
    v_mov_b32 v77, 0
    v_mov_b32 v78, 0
    v_mov_b32 v79, 0
    v_mov_b32 v80, 0
    v_mov_b32 v81, 0
    v_mov_b32 v82, 0
    v_mov_b32 v83, 0
    v_mov_b32 v84, 0
    v_mov_b32 v85, 0
    v_mov_b32 v86, 0
    v_mov_b32 v87, 0
    v_mov_b32 v88, 0
    v_mov_b32 v89, 0
    v_mov_b32 v90, 0
    v_mov_b32 v91, 0
    v_mov_b32 v92, 0
    v_mov_b32 v93, 0
    v_mov_b32 v94, 0
    v_mov_b32 v95, 0
    v_mov_b32 v96, 0
    v_mov_b32 v97, 0
    v_mov_b32 v98, 0
    v_mov_b32 v99, 0
    v_mov_b32 v100, 0
    v_mov_b32 v101, 0
    v_mov_b32 v102, 0
    v_mov_b32 v103, 0
    v_mov_b32 v104, 0
    v_mov_b32 v105, 0
    v_mov_b32 v106, 0
    v_mov_b32 v107, 0
    v_mov_b32 v108, 0
    v_mov_b32 v109, 0
    v_mov_b32 v110, 0
    v_mov_b32 v111, 0
    v_mov_b32 v112, 0
    v_mov_b32 v113, 0
    v_mov_b32 v114, 0
    v_mov_b32 v115, 0
    v_mov_b32 v116, 0
    v_mov_b32 v117, 0
    v_mov_b32 v118, 0
    v_mov_b32 v119, 0
    v_mov_b32 v120, 0
    v_mov_b32 v121, 0
    v_mov_b32 v122, 0
    v_mov_b32 v123, 0
    v_mov_b32 v124, 0
    v_mov_b32 v125, 0
    v_mov_b32 v126, 0
    v_mov_b32 v127, 0
    v_mov_b32 v128, 0
    v_mov_b32 v129, 0
    v_mov_b32 v130, 0
    v_mov_b32 v131, 0
    v_mov_b32 v132, 0
    v_mov_b32 v133, 0
    v_mov_b32 v134, 0
    v_mov_b32 v135, 0
    s_mov_b32 s54, 0
    s_mov_b32 s55, 0
    s_mov_b32 s56, 0
    v_mov_b32 v196, 0
    v_mov_b32 v197, 0
    s_mov_b32 s70, 0x3f803f80
    s_waitcnt vmcnt(5)
    v_dot2_f32_bf16 v196, v156, s70, v196
    v_dot2_f32_bf16 v197, v156, v156, v197
    v_dot2_f32_bf16 v196, v157, s70, v196
    v_dot2_f32_bf16 v197, v157, v157, v197
    v_dot2_f32_bf16 v196, v158, s70, v196
    v_dot2_f32_bf16 v197, v158, v158, v197
    v_dot2_f32_bf16 v196, v159, s70, v196
    v_dot2_f32_bf16 v197, v159, v159, v197
    v_dot2_f32_bf16 v196, v160, s70, v196
    v_dot2_f32_bf16 v197, v160, v160, v197
    v_dot2_f32_bf16 v196, v161, s70, v196
    v_dot2_f32_bf16 v197, v161, v161, v197
    v_dot2_f32_bf16 v196, v162, s70, v196
    v_dot2_f32_bf16 v197, v162, v162, v197
    v_dot2_f32_bf16 v196, v163, s70, v196
    v_dot2_f32_bf16 v197, v163, v163, v197
    v_dot2_f32_bf16 v196, v164, s70, v196
    v_dot2_f32_bf16 v197, v164, v164, v197
    v_dot2_f32_bf16 v196, v165, s70, v196
    v_dot2_f32_bf16 v197, v165, v165, v197
    v_dot2_f32_bf16 v196, v166, s70, v196
    v_dot2_f32_bf16 v197, v166, v166, v197
    v_dot2_f32_bf16 v196, v167, s70, v196
    v_dot2_f32_bf16 v197, v167, v167, v197
    v_dot2_f32_bf16 v196, v168, s70, v196
    v_dot2_f32_bf16 v197, v168, v168, v197
    v_dot2_f32_bf16 v196, v169, s70, v196
    v_dot2_f32_bf16 v197, v169, v169, v197
    v_dot2_f32_bf16 v196, v170, s70, v196
    v_dot2_f32_bf16 v197, v170, v170, v197
    v_dot2_f32_bf16 v196, v171, s70, v196
    v_dot2_f32_bf16 v197, v171, v171, v197
    v_dot2_f32_bf16 v196, v172, s70, v196
    v_dot2_f32_bf16 v197, v172, v172, v197
    v_dot2_f32_bf16 v196, v173, s70, v196
    v_dot2_f32_bf16 v197, v173, v173, v197
    v_dot2_f32_bf16 v196, v174, s70, v196
    v_dot2_f32_bf16 v197, v174, v174, v197
    v_dot2_f32_bf16 v196, v175, s70, v196
    v_dot2_f32_bf16 v197, v175, v175, v197
    s_nop 1
    v_add_f32_dpp v196, v196, v196 row_ror:8 row_mask:0xf bank_mask:0xf
    v_add_f32_dpp v197, v197, v197 row_ror:8 row_mask:0xf bank_mask:0xf
    s_nop 1
    v_add_f32_dpp v196, v196, v196 row_ror:4 row_mask:0xf bank_mask:0xf
    v_add_f32_dpp v197, v197, v197 row_ror:4 row_mask:0xf bank_mask:0xf
    s_nop 1
    v_add_f32_dpp v196, v196, v196 row_ror:2 row_mask:0xf bank_mask:0xf
    v_add_f32_dpp v197, v197, v197 row_ror:2 row_mask:0xf bank_mask:0xf
    s_nop 1
    v_add_f32_dpp v196, v196, v196 row_ror:1 row_mask:0xf bank_mask:0xf
    v_add_f32_dpp v197, v197, v197 row_ror:1 row_mask:0xf bank_mask:0xf
    s_mov_b32 s71, 0x3acccccd
    s_mov_b32 s72, 0x3727c5ac
    v_mul_f32 v196, s71, v196
    v_mul_f32 v197, s71, v197
    v_fma_f32 v197, -v196, v196, v197
    v_max_f32 v197, 0, v197
    v_add_f32 v198, s72, v197
    v_rsq_f32 v199, v198
    s_nop 0
    v_mul_f32 v200, v199, v199
    v_mul_f32 v200, v200, v197
    v_add_f32 v200, s72, v200
    v_rsq_f32 v200, v200
    s_nop 0
    v_mul_f32 v203, v199, v200
    v_rcp_f32 v201, v203
    v_sub_f32 v204, 0, v196
    v_and_b32 v205, 0xffff0000, v204
    v_sub_f32 v206, v204, v205
    v_cvt_pk_bf16_f32 v200, v205, v206
    v_and_b32 v205, 0xffff0000, v201
    v_sub_f32 v206, v201, v205
    v_cvt_pk_bf16_f32 v201, v205, v206
    v_mov_b32 v202, v199
    v_lshlrev_b32 v151, 4, v146
    v_add_u32 v151, 29360128, v151
    v_mov_b32 v152, 2048
    v_cmp_eq_u32 vcc, 0, v145
    v_cmp_gt_u32 s[74:75], 9, v144
    v_cmp_lt_u32 s[76:77], v146, v152
    s_nop 1
    s_and_b64 vcc, vcc, s[74:75]
    s_and_b64 vcc, vcc, s[76:77]
    s_nop 1
    v_cndmask_b32 v151, v148, v151, vcc
    s_waitcnt vmcnt(0)
    buffer_store_dwordx4 v[200:203], v151, s[24:27], 0 offen sc1
    v_mov_b32 v156, 0
    v_mov_b32 v157, 0
    v_mov_b32 v158, 0
    v_mov_b32 v159, 0
    v_mov_b32 v160, 0
    v_mov_b32 v161, 0
    v_mov_b32 v162, 0
    v_mov_b32 v163, 0
    s_mov_b32 s70, 0x00003f80
    s_mov_b32 s71, 0x3f800000
    s_waitcnt vmcnt(63)
    v_dot2_f32_bf16 v156, v176, s70, v156
    v_dot2_f32_bf16 v157, v176, s71, v157
    v_dot2_f32_bf16 v158, v177, s70, v158
    v_dot2_f32_bf16 v159, v177, s71, v159
    v_dot2_f32_bf16 v160, v178, s70, v160
    v_dot2_f32_bf16 v161, v178, s71, v161
    v_dot2_f32_bf16 v162, v179, s70, v162
    v_dot2_f32_bf16 v163, v179, s71, v163
    v_dot2_f32_bf16 v156, v180, s70, v156
    v_dot2_f32_bf16 v157, v180, s71, v157
    v_dot2_f32_bf16 v158, v181, s70, v158
    v_dot2_f32_bf16 v159, v181, s71, v159
    v_dot2_f32_bf16 v160, v182, s70, v160
    v_dot2_f32_bf16 v161, v182, s71, v161
    v_dot2_f32_bf16 v162, v183, s70, v162
    v_dot2_f32_bf16 v163, v183, s71, v163
    v_dot2_f32_bf16 v156, v184, s70, v156
    v_dot2_f32_bf16 v157, v184, s71, v157
    v_dot2_f32_bf16 v158, v185, s70, v158
    v_dot2_f32_bf16 v159, v185, s71, v159
    v_dot2_f32_bf16 v160, v186, s70, v160
    v_dot2_f32_bf16 v161, v186, s71, v161
    v_dot2_f32_bf16 v162, v187, s70, v162
    v_dot2_f32_bf16 v163, v187, s71, v163
    v_dot2_f32_bf16 v156, v188, s70, v156
    v_dot2_f32_bf16 v157, v188, s71, v157
    v_dot2_f32_bf16 v158, v189, s70, v158
    v_dot2_f32_bf16 v159, v189, s71, v159
    v_dot2_f32_bf16 v160, v190, s70, v160
    v_dot2_f32_bf16 v161, v190, s71, v161
    v_dot2_f32_bf16 v162, v191, s70, v162
    v_dot2_f32_bf16 v163, v191, s71, v163
    v_dot2_f32_bf16 v156, v192, s70, v156
    v_dot2_f32_bf16 v157, v192, s71, v157
    v_dot2_f32_bf16 v158, v193, s70, v158
    v_dot2_f32_bf16 v159, v193, s71, v159
    v_dot2_f32_bf16 v160, v194, s70, v160
    v_dot2_f32_bf16 v161, v194, s71, v161
    v_dot2_f32_bf16 v162, v195, s70, v162
    v_dot2_f32_bf16 v163, v195, s71, v163
    s_lshl_b32 s67, s40, 11
    s_add_u32 s67, s67, 147456
    v_lshlrev_b32 v153, 5, v1
    v_add_u32 v153, s67, v153
    ds_write_b128 v153, v[156:159]
    ds_write_b128 v153, v[160:163] offset:16
    v_lshlrev_b32 v154, 2, v1
    v_add_u32 v154, s67, v154
    s_waitcnt lgkmcnt(0)
    ds_read_b32 v164, v154 offset:0
    ds_read_b32 v165, v154 offset:256
    ds_read_b32 v166, v154 offset:512
    ds_read_b32 v167, v154 offset:768
    ds_read_b32 v168, v154 offset:1024
    ds_read_b32 v169, v154 offset:1280
    ds_read_b32 v170, v154 offset:1536
    ds_read_b32 v171, v154 offset:1792
    s_lshl_b32 s67, s63, 6
    v_add_u32 v155, s67, v1
    v_lshlrev_b32 v155, 2, v155
    s_lshl_b32 s67, s64, 2
    s_add_u32 s67, s67, s40
    s_mul_i32 s67, s67, 14848
    s_add_u32 s67, s67, 29884416
    s_cmp_lt_u32 s82, 228
    s_cselect_b32 s67, s67, 2146435072
    v_add_u32 v155, s67, v155
    s_waitcnt lgkmcnt(0)
    v_add_f32 v164, v164, v165
    v_add_f32 v164, v164, v166
    v_add_f32 v164, v164, v167
    v_add_f32 v164, v164, v168
    v_add_f32 v164, v164, v169
    v_add_f32 v164, v164, v170
    v_add_f32 v164, v164, v171
    buffer_store_dword v164, v155, s[24:27], 0 offen sc1
    s_barrier
    v_mov_b32 v4, v2
    v_mov_b32 v5, v3
    v_mov_b32 v216, v208
    v_mov_b32 v217, v209
    v_mov_b32 v218, v210
    v_mov_b32 v219, v211
    v_mov_b32 v220, v212
    v_mov_b32 v221, v213
    v_mov_b32 v222, v214
    v_mov_b32 v223, v215
    ds_read_b128 v[144:147], v4 offset:0
    ds_read_b64_tr_b16 v[176:177], v216 offset:0
    ds_read_b64_tr_b16 v[178:179], v216 offset:2048
    ds_read_b128 v[148:151], v4 offset:2048
    ds_read_b128 v[152:155], v4 offset:4096
    ds_read_b128 v[156:159], v4 offset:6144
    ds_read_b64_tr_b16 v[180:181], v217 offset:0
    ds_read_b64_tr_b16 v[182:183], v217 offset:2048
    ds_read_b64_tr_b16 v[184:185], v218 offset:0
    ds_read_b64_tr_b16 v[186:187], v218 offset:2048
    ds_read_b64_tr_b16 v[188:189], v219 offset:0
    ds_read_b64_tr_b16 v[190:191], v219 offset:2048
    ds_read_b64_tr_b16 v[192:193], v220 offset:0
    ds_read_b64_tr_b16 v[194:195], v220 offset:2048
    s_mov_b32 s60, 9
k1_kernel_q_loop:
    s_waitcnt lgkmcnt(11)
    v_mfma_f32_16x16x32_bf16 v[16:19], v[176:179], v[144:147], v[16:19]
    ds_read_b64_tr_b16 v[196:197], v221 offset:0
    ds_read_b64_tr_b16 v[198:199], v221 offset:2048
    s_waitcnt lgkmcnt(12)
    v_mfma_f32_16x16x32_bf16 v[20:23], v[176:179], v[148:151], v[20:23]
    s_add_u32 s56, s56, 1
    s_cmp_eq_u32 s56, 3
    s_waitcnt lgkmcnt(11)
    v_mfma_f32_16x16x32_bf16 v[24:27], v[176:179], v[152:155], v[24:27]
    s_cselect_b32 s58, 98304, 0
    s_cselect_b32 s59, 49152, 0
    s_waitcnt lgkmcnt(10)
    v_mfma_f32_16x16x32_bf16 v[28:31], v[176:179], v[156:159], v[28:31]
    s_cselect_b32 s56, 0, s56
    s_waitcnt lgkmcnt(8)
    v_mfma_f32_16x16x32_bf16 v[32:35], v[180:183], v[144:147], v[32:35]
    ds_read_b64_tr_b16 v[200:201], v222 offset:0
    v_mfma_f32_16x16x32_bf16 v[36:39], v[180:183], v[148:151], v[36:39]
    ds_read_b64_tr_b16 v[202:203], v222 offset:2048
    v_mfma_f32_16x16x32_bf16 v[40:43], v[180:183], v[152:155], v[40:43]
    ds_read_b128 v[160:163], v5 offset:0
    v_mfma_f32_16x16x32_bf16 v[44:47], v[180:183], v[156:159], v[44:47]
    s_waitcnt lgkmcnt(9)
    v_mfma_f32_16x16x32_bf16 v[48:51], v[184:187], v[144:147], v[48:51]
    ds_read_b64_tr_b16 v[204:205], v223 offset:0
    v_mfma_f32_16x16x32_bf16 v[52:55], v[184:187], v[148:151], v[52:55]
    ds_read_b64_tr_b16 v[206:207], v223 offset:2048
    v_mfma_f32_16x16x32_bf16 v[56:59], v[184:187], v[152:155], v[56:59]
    ds_read_b128 v[164:167], v5 offset:2048
    v_mfma_f32_16x16x32_bf16 v[60:63], v[184:187], v[156:159], v[60:63]
    s_waitcnt lgkmcnt(10)
    v_mfma_f32_16x16x32_bf16 v[64:67], v[188:191], v[144:147], v[64:67]
    ds_read_b64_tr_b16 v[176:177], v216 offset:16384
    v_mfma_f32_16x16x32_bf16 v[68:71], v[188:191], v[148:151], v[68:71]
    ds_read_b64_tr_b16 v[178:179], v216 offset:18432
    v_mfma_f32_16x16x32_bf16 v[72:75], v[188:191], v[152:155], v[72:75]
    ds_read_b128 v[168:171], v5 offset:4096
    v_mfma_f32_16x16x32_bf16 v[76:79], v[188:191], v[156:159], v[76:79]
    s_waitcnt lgkmcnt(11)
    v_mfma_f32_16x16x32_bf16 v[80:83], v[192:195], v[144:147], v[80:83]
    ds_read_b64_tr_b16 v[180:181], v217 offset:16384
    v_mfma_f32_16x16x32_bf16 v[84:87], v[192:195], v[148:151], v[84:87]
    ds_read_b64_tr_b16 v[182:183], v217 offset:18432
    v_mfma_f32_16x16x32_bf16 v[88:91], v[192:195], v[152:155], v[88:91]
    ds_read_b128 v[172:175], v5 offset:6144
    v_mfma_f32_16x16x32_bf16 v[92:95], v[192:195], v[156:159], v[92:95]
    s_waitcnt lgkmcnt(12)
    v_mfma_f32_16x16x32_bf16 v[96:99], v[196:199], v[144:147], v[96:99]
    ds_read_b64_tr_b16 v[184:185], v218 offset:16384
    ds_read_b64_tr_b16 v[186:187], v218 offset:18432
    v_mfma_f32_16x16x32_bf16 v[100:103], v[196:199], v[148:151], v[100:103]
    s_add_u32 s54, s54, 32768
    s_sub_u32 s54, s54, s58
    v_mfma_f32_16x16x32_bf16 v[104:107], v[196:199], v[152:155], v[104:107]
    s_add_u32 s55, s55, 16384
    s_sub_u32 s55, s55, s59
    v_mfma_f32_16x16x32_bf16 v[108:111], v[196:199], v[156:159], v[108:111]
    s_waitcnt lgkmcnt(12)
    v_mfma_f32_16x16x32_bf16 v[112:115], v[200:203], v[144:147], v[112:115]
    ds_read_b64_tr_b16 v[188:189], v219 offset:16384
    v_mfma_f32_16x16x32_bf16 v[116:119], v[200:203], v[148:151], v[116:119]
    ds_read_b64_tr_b16 v[190:191], v219 offset:18432
    v_mfma_f32_16x16x32_bf16 v[120:123], v[200:203], v[152:155], v[120:123]
    v_add_u32 v216, s54, v208
    v_mfma_f32_16x16x32_bf16 v[124:127], v[200:203], v[156:159], v[124:127]
    s_waitcnt lgkmcnt(11)
    s_cmp_eq_u32 s51, 0
    s_cbranch_scc0 k1_kernel_q_b7_4
    v_mfma_f32_16x16x32_bf16 v[128:131], v[204:207], v[144:147], v[128:131]
    v_mfma_f32_16x16x32_bf16 v[132:135], v[204:207], v[148:151], v[132:135]
    s_branch k1_kernel_q_b7_5
k1_kernel_q_b7_4:
    v_mfma_f32_16x16x32_bf16 v[128:131], v[204:207], v[152:155], v[128:131]
    v_mfma_f32_16x16x32_bf16 v[132:135], v[204:207], v[156:159], v[132:135]
k1_kernel_q_b7_5:
    ds_read_b64_tr_b16 v[192:193], v220 offset:16384
    ds_read_b64_tr_b16 v[194:195], v220 offset:18432
    s_waitcnt lgkmcnt(10)
    v_mfma_f32_16x16x32_bf16 v[16:19], v[176:179], v[160:163], v[16:19]
    v_add_u32 v217, s54, v209
    v_mfma_f32_16x16x32_bf16 v[20:23], v[176:179], v[164:167], v[20:23]
    ds_read_b64_tr_b16 v[196:197], v221 offset:16384
    s_waitcnt lgkmcnt(10)
    v_mfma_f32_16x16x32_bf16 v[24:27], v[176:179], v[168:171], v[24:27]
    ds_read_b64_tr_b16 v[198:199], v221 offset:18432
    s_waitcnt lgkmcnt(8)
    v_mfma_f32_16x16x32_bf16 v[28:31], v[176:179], v[172:175], v[28:31]
    v_add_u32 v218, s54, v210
    v_mfma_f32_16x16x32_bf16 v[32:35], v[180:183], v[160:163], v[32:35]
    ds_read_b64_tr_b16 v[200:201], v222 offset:16384
    v_mfma_f32_16x16x32_bf16 v[36:39], v[180:183], v[164:167], v[36:39]
    ds_read_b64_tr_b16 v[202:203], v222 offset:18432
    v_mfma_f32_16x16x32_bf16 v[40:43], v[180:183], v[168:171], v[40:43]
    v_add_u32 v219, s54, v211
    v_mfma_f32_16x16x32_bf16 v[44:47], v[180:183], v[172:175], v[44:47]
    s_waitcnt lgkmcnt(8)
    v_mfma_f32_16x16x32_bf16 v[48:51], v[184:187], v[160:163], v[48:51]
    ds_read_b64_tr_b16 v[204:205], v223 offset:16384
    v_mfma_f32_16x16x32_bf16 v[52:55], v[184:187], v[164:167], v[52:55]
    ds_read_b64_tr_b16 v[206:207], v223 offset:18432
    v_mfma_f32_16x16x32_bf16 v[56:59], v[184:187], v[168:171], v[56:59]
    v_add_u32 v220, s54, v212
    v_mfma_f32_16x16x32_bf16 v[60:63], v[184:187], v[172:175], v[60:63]
    s_waitcnt lgkmcnt(8)
    v_mfma_f32_16x16x32_bf16 v[64:67], v[188:191], v[160:163], v[64:67]
    v_add_u32 v221, s54, v213
    v_mfma_f32_16x16x32_bf16 v[68:71], v[188:191], v[164:167], v[68:71]
    v_add_u32 v4, s55, v2
    v_mfma_f32_16x16x32_bf16 v[72:75], v[188:191], v[168:171], v[72:75]
    v_mfma_f32_16x16x32_bf16 v[76:79], v[188:191], v[172:175], v[76:79]
    s_waitcnt lgkmcnt(6)
    v_mfma_f32_16x16x32_bf16 v[80:83], v[192:195], v[160:163], v[80:83]
    v_add_u32 v222, s54, v214
    v_mfma_f32_16x16x32_bf16 v[84:87], v[192:195], v[164:167], v[84:87]
    v_add_u32 v5, s55, v3
    v_mfma_f32_16x16x32_bf16 v[88:91], v[192:195], v[168:171], v[88:91]
    v_add_u32 v223, s54, v215
    v_mfma_f32_16x16x32_bf16 v[92:95], v[192:195], v[172:175], v[92:95]
    s_waitcnt lgkmcnt(0)
    s_cmp_eq_u32 s60, 8
    s_cbranch_scc0 k1_kernel_q_hk_8
    s_waitcnt vmcnt(0)
k1_kernel_q_hk_8:
    s_cmp_le_u32 s60, 3
    s_cbranch_scc0 k1_kernel_q_hk_7
    s_cmp_eq_u32 s40, 0
    s_cbranch_scc0 k1_kernel_q_hk_7
    v_mov_b32 v10, 0
    s_cmp_eq_u32 s60, 3
    s_cbranch_scc0 k1_kernel_q_hk_6
    global_load_dword v11, v10, s[80:81] sc1
    global_load_dword v12, v10, s[80:81] offset:128 sc1
    s_branch k1_kernel_q_hk_7
k1_kernel_q_hk_6:
    s_cmp_eq_u32 s60, 2
    s_cbranch_scc0 k1_kernel_q_hk_7
    s_mov_b32 s72, 1048576
k1_kernel_q_hk_6_c:
    s_waitcnt vmcnt(0)
    v_min_u32 v11, v11, v12
    s_nop 0
    v_readfirstlane_b32 s73, v11
    s_cmp_ge_u32 s73, 114
    s_cbranch_scc1 k1_kernel_q_hk_7
    s_sub_u32 s72, s72, 1
    s_cmp_eq_u32 s72, 0
    s_cbranch_scc1 k1_kernel_q_hk_7
    s_sleep 8
    global_load_dword v11, v10, s[80:81] sc1
    global_load_dword v12, v10, s[80:81] offset:128 sc1
    s_branch k1_kernel_q_hk_6_c
k1_kernel_q_hk_7:
    s_barrier
    v_mfma_f32_16x16x32_bf16 v[96:99], v[196:199], v[160:163], v[96:99]
    ds_read_b128 v[144:147], v4 offset:0
    ds_read_b64_tr_b16 v[176:177], v216 offset:0
    v_mfma_f32_16x16x32_bf16 v[100:103], v[196:199], v[164:167], v[100:103]
    ds_read_b64_tr_b16 v[178:179], v216 offset:2048
    ds_read_b128 v[148:151], v4 offset:2048
    v_mfma_f32_16x16x32_bf16 v[104:107], v[196:199], v[168:171], v[104:107]
    ds_read_b128 v[152:155], v4 offset:4096
    ds_read_b128 v[156:159], v4 offset:6144
    v_mfma_f32_16x16x32_bf16 v[108:111], v[196:199], v[172:175], v[108:111]
    ds_read_b64_tr_b16 v[180:181], v217 offset:0
    ds_read_b64_tr_b16 v[182:183], v217 offset:2048
    v_mfma_f32_16x16x32_bf16 v[112:115], v[200:203], v[160:163], v[112:115]
    ds_read_b64_tr_b16 v[184:185], v218 offset:0
    ds_read_b64_tr_b16 v[186:187], v218 offset:2048
    v_mfma_f32_16x16x32_bf16 v[116:119], v[200:203], v[164:167], v[116:119]
    ds_read_b64_tr_b16 v[188:189], v219 offset:0
    ds_read_b64_tr_b16 v[190:191], v219 offset:2048
    v_mfma_f32_16x16x32_bf16 v[120:123], v[200:203], v[168:171], v[120:123]
    ds_read_b64_tr_b16 v[192:193], v220 offset:0
    ds_read_b64_tr_b16 v[194:195], v220 offset:2048
    v_mfma_f32_16x16x32_bf16 v[124:127], v[200:203], v[172:175], v[124:127]
    s_cmp_eq_u32 s51, 0
    s_cbranch_scc0 k1_kernel_q_b7_9
    v_mfma_f32_16x16x32_bf16 v[128:131], v[204:207], v[160:163], v[128:131]
    v_mfma_f32_16x16x32_bf16 v[132:135], v[204:207], v[164:167], v[132:135]
    s_branch k1_kernel_q_b7_10
k1_kernel_q_b7_9:
    v_mfma_f32_16x16x32_bf16 v[128:131], v[204:207], v[168:171], v[128:131]
    v_mfma_f32_16x16x32_bf16 v[132:135], v[204:207], v[172:175], v[132:135]
k1_kernel_q_b7_10:
    s_sub_u32 s60, s60, 1
    s_cmp_lg_u32 s60, 0
    s_cbranch_scc1 k1_kernel_q_loop
    s_waitcnt lgkmcnt(11)
    v_mfma_f32_16x16x32_bf16 v[16:19], v[176:179], v[144:147], v[16:19]
    ds_read_b64_tr_b16 v[196:197], v221 offset:0
    s_waitcnt lgkmcnt(11)
    v_mfma_f32_16x16x32_bf16 v[20:23], v[176:179], v[148:151], v[20:23]
    ds_read_b64_tr_b16 v[198:199], v221 offset:2048
    s_waitcnt lgkmcnt(11)
    v_mfma_f32_16x16x32_bf16 v[24:27], v[176:179], v[152:155], v[24:27]
    s_waitcnt lgkmcnt(10)
    v_mfma_f32_16x16x32_bf16 v[28:31], v[176:179], v[156:159], v[28:31]
    s_waitcnt lgkmcnt(8)
    v_mfma_f32_16x16x32_bf16 v[32:35], v[180:183], v[144:147], v[32:35]
    ds_read_b64_tr_b16 v[200:201], v222 offset:0
    v_mfma_f32_16x16x32_bf16 v[36:39], v[180:183], v[148:151], v[36:39]
    ds_read_b64_tr_b16 v[202:203], v222 offset:2048
    v_mfma_f32_16x16x32_bf16 v[40:43], v[180:183], v[152:155], v[40:43]
    ds_read_b128 v[160:163], v5 offset:0
    v_mfma_f32_16x16x32_bf16 v[44:47], v[180:183], v[156:159], v[44:47]
    s_waitcnt lgkmcnt(9)
    v_mfma_f32_16x16x32_bf16 v[48:51], v[184:187], v[144:147], v[48:51]
    ds_read_b64_tr_b16 v[204:205], v223 offset:0
    v_mfma_f32_16x16x32_bf16 v[52:55], v[184:187], v[148:151], v[52:55]
    ds_read_b64_tr_b16 v[206:207], v223 offset:2048
    v_mfma_f32_16x16x32_bf16 v[56:59], v[184:187], v[152:155], v[56:59]
    ds_read_b128 v[164:167], v5 offset:2048
    v_mfma_f32_16x16x32_bf16 v[60:63], v[184:187], v[156:159], v[60:63]
    s_waitcnt lgkmcnt(10)
    v_mfma_f32_16x16x32_bf16 v[64:67], v[188:191], v[144:147], v[64:67]
    ds_read_b64_tr_b16 v[176:177], v216 offset:16384
    v_mfma_f32_16x16x32_bf16 v[68:71], v[188:191], v[148:151], v[68:71]
    ds_read_b64_tr_b16 v[178:179], v216 offset:18432
    v_mfma_f32_16x16x32_bf16 v[72:75], v[188:191], v[152:155], v[72:75]
    ds_read_b128 v[168:171], v5 offset:4096
    v_mfma_f32_16x16x32_bf16 v[76:79], v[188:191], v[156:159], v[76:79]
    s_waitcnt lgkmcnt(11)
    v_mfma_f32_16x16x32_bf16 v[80:83], v[192:195], v[144:147], v[80:83]
    ds_read_b64_tr_b16 v[180:181], v217 offset:16384
    v_mfma_f32_16x16x32_bf16 v[84:87], v[192:195], v[148:151], v[84:87]
    ds_read_b64_tr_b16 v[182:183], v217 offset:18432
    v_mfma_f32_16x16x32_bf16 v[88:91], v[192:195], v[152:155], v[88:91]
    ds_read_b128 v[172:175], v5 offset:6144
    v_mfma_f32_16x16x32_bf16 v[92:95], v[192:195], v[156:159], v[92:95]
    s_waitcnt lgkmcnt(12)
    v_mfma_f32_16x16x32_bf16 v[96:99], v[196:199], v[144:147], v[96:99]
    ds_read_b64_tr_b16 v[184:185], v218 offset:16384
    v_mfma_f32_16x16x32_bf16 v[100:103], v[196:199], v[148:151], v[100:103]
    ds_read_b64_tr_b16 v[186:187], v218 offset:18432
    v_mfma_f32_16x16x32_bf16 v[104:107], v[196:199], v[152:155], v[104:107]
    v_mfma_f32_16x16x32_bf16 v[108:111], v[196:199], v[156:159], v[108:111]
    s_waitcnt lgkmcnt(12)
    v_mfma_f32_16x16x32_bf16 v[112:115], v[200:203], v[144:147], v[112:115]
    ds_read_b64_tr_b16 v[188:189], v219 offset:16384
    v_mfma_f32_16x16x32_bf16 v[116:119], v[200:203], v[148:151], v[116:119]
    ds_read_b64_tr_b16 v[190:191], v219 offset:18432
    v_mfma_f32_16x16x32_bf16 v[120:123], v[200:203], v[152:155], v[120:123]
    v_mfma_f32_16x16x32_bf16 v[124:127], v[200:203], v[156:159], v[124:127]
    s_waitcnt lgkmcnt(11)
    s_cmp_eq_u32 s51, 0
    s_cbranch_scc0 k1_kernel_q_b7_11
    v_mfma_f32_16x16x32_bf16 v[128:131], v[204:207], v[144:147], v[128:131]
    v_mfma_f32_16x16x32_bf16 v[132:135], v[204:207], v[148:151], v[132:135]
    s_branch k1_kernel_q_b7_12
k1_kernel_q_b7_11:
    v_mfma_f32_16x16x32_bf16 v[128:131], v[204:207], v[152:155], v[128:131]
    v_mfma_f32_16x16x32_bf16 v[132:135], v[204:207], v[156:159], v[132:135]
k1_kernel_q_b7_12:
    ds_read_b64_tr_b16 v[192:193], v220 offset:16384
    ds_read_b64_tr_b16 v[194:195], v220 offset:18432
    s_waitcnt lgkmcnt(10)
    v_mfma_f32_16x16x32_bf16 v[16:19], v[176:179], v[160:163], v[16:19]
    ds_read_b64_tr_b16 v[196:197], v221 offset:16384
    v_mfma_f32_16x16x32_bf16 v[20:23], v[176:179], v[164:167], v[20:23]
    ds_read_b64_tr_b16 v[198:199], v221 offset:18432
    s_waitcnt lgkmcnt(11)
    v_mfma_f32_16x16x32_bf16 v[24:27], v[176:179], v[168:171], v[24:27]
    s_waitcnt lgkmcnt(8)
    v_mfma_f32_16x16x32_bf16 v[28:31], v[176:179], v[172:175], v[28:31]
    v_mfma_f32_16x16x32_bf16 v[32:35], v[180:183], v[160:163], v[32:35]
    ds_read_b64_tr_b16 v[200:201], v222 offset:16384
    v_mfma_f32_16x16x32_bf16 v[36:39], v[180:183], v[164:167], v[36:39]
    ds_read_b64_tr_b16 v[202:203], v222 offset:18432
    v_mfma_f32_16x16x32_bf16 v[40:43], v[180:183], v[168:171], v[40:43]
    v_mfma_f32_16x16x32_bf16 v[44:47], v[180:183], v[172:175], v[44:47]
    s_waitcnt lgkmcnt(8)
    v_mfma_f32_16x16x32_bf16 v[48:51], v[184:187], v[160:163], v[48:51]
    ds_read_b64_tr_b16 v[204:205], v223 offset:16384
    v_mfma_f32_16x16x32_bf16 v[52:55], v[184:187], v[164:167], v[52:55]
    ds_read_b64_tr_b16 v[206:207], v223 offset:18432
    v_mfma_f32_16x16x32_bf16 v[56:59], v[184:187], v[168:171], v[56:59]
    v_mfma_f32_16x16x32_bf16 v[60:63], v[184:187], v[172:175], v[60:63]
    s_waitcnt lgkmcnt(8)
    v_mfma_f32_16x16x32_bf16 v[64:67], v[188:191], v[160:163], v[64:67]
    v_mfma_f32_16x16x32_bf16 v[68:71], v[188:191], v[164:167], v[68:71]
    v_mfma_f32_16x16x32_bf16 v[72:75], v[188:191], v[168:171], v[72:75]
    v_mfma_f32_16x16x32_bf16 v[76:79], v[188:191], v[172:175], v[76:79]
    s_waitcnt lgkmcnt(6)
    v_mfma_f32_16x16x32_bf16 v[80:83], v[192:195], v[160:163], v[80:83]
    v_mfma_f32_16x16x32_bf16 v[84:87], v[192:195], v[164:167], v[84:87]
    v_mfma_f32_16x16x32_bf16 v[88:91], v[192:195], v[168:171], v[88:91]
    v_mfma_f32_16x16x32_bf16 v[92:95], v[192:195], v[172:175], v[92:95]
    s_waitcnt lgkmcnt(4)
    v_mfma_f32_16x16x32_bf16 v[96:99], v[196:199], v[160:163], v[96:99]
    v_mfma_f32_16x16x32_bf16 v[100:103], v[196:199], v[164:167], v[100:103]
    v_mfma_f32_16x16x32_bf16 v[104:107], v[196:199], v[168:171], v[104:107]
    v_mfma_f32_16x16x32_bf16 v[108:111], v[196:199], v[172:175], v[108:111]
    s_waitcnt lgkmcnt(2)
    v_mfma_f32_16x16x32_bf16 v[112:115], v[200:203], v[160:163], v[112:115]
    v_mfma_f32_16x16x32_bf16 v[116:119], v[200:203], v[164:167], v[116:119]
    v_mfma_f32_16x16x32_bf16 v[120:123], v[200:203], v[168:171], v[120:123]
    v_mfma_f32_16x16x32_bf16 v[124:127], v[200:203], v[172:175], v[124:127]
    s_waitcnt lgkmcnt(0)
    s_cmp_eq_u32 s51, 0
    s_cbranch_scc0 k1_kernel_q_b7_13
    v_mfma_f32_16x16x32_bf16 v[128:131], v[204:207], v[160:163], v[128:131]
    v_mfma_f32_16x16x32_bf16 v[132:135], v[204:207], v[164:167], v[132:135]
    s_branch k1_kernel_q_b7_14
k1_kernel_q_b7_13:
    v_mfma_f32_16x16x32_bf16 v[128:131], v[204:207], v[168:171], v[128:131]
    v_mfma_f32_16x16x32_bf16 v[132:135], v[204:207], v[172:175], v[132:135]
k1_kernel_q_b7_14:
    s_barrier
    v_and_b32 v8, 15, v1
    v_lshrrev_b32 v9, 4, v1
    v_add_u32 v10, s52, v8
    v_lshlrev_b32 v11, 4, v10
    v_add_u32 v11, 147456, v11
    ds_read_b128 v[144:147], v11 offset:0
    ds_read_b128 v[148:151], v11 offset:256
    ds_read_b128 v[152:155], v11 offset:512
    ds_read_b128 v[156:159], v11 offset:768
    v_lshrrev_b32 v12, 2, v8
    v_and_b32 v13, 3, v8
    v_mul_u32_u24 v12, 20, v12
    v_add_u32 v12, v12, v13
    s_mul_i32 s53, s51, 80
    v_mov_b32 v14, 159744
    v_cmp_eq_u32 s[58:59], 0, v9
    v_add_u32 v15, s53, v12
    v_add_u32 v15, 0, v15
    v_lshlrev_b32 v15, 4, v15
    v_add_u32 v15, 151552, v15
    v_cndmask_b32 v15, v14, v15, s[58:59]
    ds_read_b128 v[176:179], v15
    v_add_u32 v15, s53, v12
    v_add_u32 v15, 4, v15
    v_lshlrev_b32 v15, 4, v15
    v_add_u32 v15, 151552, v15
    v_cndmask_b32 v15, v14, v15, s[58:59]
    ds_read_b128 v[180:183], v15
    v_add_u32 v15, s53, v12
    v_add_u32 v15, 8, v15
    v_lshlrev_b32 v15, 4, v15
    v_add_u32 v15, 151552, v15
    v_cndmask_b32 v15, v14, v15, s[58:59]
    ds_read_b128 v[184:187], v15
    v_add_u32 v15, s53, v12
    v_add_u32 v15, 12, v15
    v_lshlrev_b32 v15, 4, v15
    v_add_u32 v15, 151552, v15
    v_cndmask_b32 v15, v14, v15, s[58:59]
    ds_read_b128 v[188:191], v15
    v_add_u32 v15, s53, v12
    v_add_u32 v15, 16, v15
    v_lshlrev_b32 v15, 4, v15
    v_add_u32 v15, 151552, v15
    v_cndmask_b32 v15, v14, v15, s[58:59]
    ds_read_b128 v[192:195], v15
    s_mul_i32 s54, s51, 12
    s_add_u32 s54, s54, 160
    v_add_u32 v15, s54, v12
    v_lshlrev_b32 v15, 4, v15
    v_add_u32 v15, 151552, v15
    v_cndmask_b32 v15, v14, v15, s[58:59]
    ds_read_b128 v[196:199], v15
    s_mul_i32 s54, s51, 12
    s_add_u32 s54, s54, 164
    v_add_u32 v15, s54, v12
    v_lshlrev_b32 v15, 4, v15
    v_add_u32 v15, 151552, v15
    v_cndmask_b32 v15, v14, v15, s[58:59]
    ds_read_b128 v[200:203], v15
    v_add_u32 v15, 168, v12
    v_lshlrev_b32 v15, 4, v15
    v_add_u32 v15, 151552, v15
    v_cndmask_b32 v15, v14, v15, s[58:59]
    ds_read_b128 v[204:207], v15
    ds_read_b128 v[224:227], v11 offset:2048
    ds_read_b128 v[228:231], v11 offset:2304
    ds_read_b128 v[232:235], v11 offset:2560
    ds_read_b128 v[236:239], v11 offset:2816
    s_waitcnt lgkmcnt(4)
    v_mfma_f32_16x16x32_bf16 v[16:19], v[176:179], v[144:147], v[16:19]
    v_mfma_f32_16x16x32_bf16 v[20:23], v[176:179], v[148:151], v[20:23]
    v_mfma_f32_16x16x32_bf16 v[24:27], v[176:179], v[152:155], v[24:27]
    v_mfma_f32_16x16x32_bf16 v[28:31], v[176:179], v[156:159], v[28:31]
    v_mfma_f32_16x16x32_bf16 v[32:35], v[180:183], v[144:147], v[32:35]
    v_mfma_f32_16x16x32_bf16 v[36:39], v[180:183], v[148:151], v[36:39]
    v_mfma_f32_16x16x32_bf16 v[40:43], v[180:183], v[152:155], v[40:43]
    v_mfma_f32_16x16x32_bf16 v[44:47], v[180:183], v[156:159], v[44:47]
    v_mfma_f32_16x16x32_bf16 v[48:51], v[184:187], v[144:147], v[48:51]
    v_mfma_f32_16x16x32_bf16 v[52:55], v[184:187], v[148:151], v[52:55]
    v_mfma_f32_16x16x32_bf16 v[56:59], v[184:187], v[152:155], v[56:59]
    v_mfma_f32_16x16x32_bf16 v[60:63], v[184:187], v[156:159], v[60:63]
    v_mfma_f32_16x16x32_bf16 v[64:67], v[188:191], v[144:147], v[64:67]
    v_mfma_f32_16x16x32_bf16 v[68:71], v[188:191], v[148:151], v[68:71]
    v_mfma_f32_16x16x32_bf16 v[72:75], v[188:191], v[152:155], v[72:75]
    v_mfma_f32_16x16x32_bf16 v[76:79], v[188:191], v[156:159], v[76:79]
    v_mfma_f32_16x16x32_bf16 v[80:83], v[192:195], v[144:147], v[80:83]
    v_mfma_f32_16x16x32_bf16 v[84:87], v[192:195], v[148:151], v[84:87]
    v_mfma_f32_16x16x32_bf16 v[88:91], v[192:195], v[152:155], v[88:91]
    v_mfma_f32_16x16x32_bf16 v[92:95], v[192:195], v[156:159], v[92:95]
    v_mfma_f32_16x16x32_bf16 v[96:99], v[196:199], v[144:147], v[96:99]
    v_mfma_f32_16x16x32_bf16 v[100:103], v[196:199], v[148:151], v[100:103]
    v_mfma_f32_16x16x32_bf16 v[104:107], v[196:199], v[152:155], v[104:107]
    v_mfma_f32_16x16x32_bf16 v[108:111], v[196:199], v[156:159], v[108:111]
    v_mfma_f32_16x16x32_bf16 v[112:115], v[200:203], v[144:147], v[112:115]
    v_mfma_f32_16x16x32_bf16 v[116:119], v[200:203], v[148:151], v[116:119]
    v_mfma_f32_16x16x32_bf16 v[120:123], v[200:203], v[152:155], v[120:123]
    v_mfma_f32_16x16x32_bf16 v[124:127], v[200:203], v[156:159], v[124:127]
    s_cmp_eq_u32 s51, 0
    s_cbranch_scc0 k1_kernel_q_c7_15
    v_mfma_f32_16x16x32_bf16 v[128:131], v[204:207], v[144:147], v[128:131]
    v_mfma_f32_16x16x32_bf16 v[132:135], v[204:207], v[148:151], v[132:135]
    s_branch k1_kernel_q_c7_16
k1_kernel_q_c7_15:
    v_mfma_f32_16x16x32_bf16 v[128:131], v[204:207], v[152:155], v[128:131]
    v_mfma_f32_16x16x32_bf16 v[132:135], v[204:207], v[156:159], v[132:135]
k1_kernel_q_c7_16:
    s_waitcnt lgkmcnt(0)
    v_mul_u32_u24 v11, 496, v10
    s_cmp_eq_u32 s51, 0
    s_cbranch_scc0 k1_kernel_q_kw
    s_nop 2
    v_mul_u32_u24 v4, 40, v9
    v_add_u32 v4, v4, v11
    v_add_u32 v4, 320, v4
    s_mul_i32 s53, s51, 24
    v_add_u32 v5, s53, v4
    v_pk_mul_f32 v[96:97], v[96:97], v[224:225] op_sel_hi:[1,0]
    v_pk_mul_f32 v[98:99], v[98:99], v[224:225] op_sel_hi:[1,0]
    v_cvt_pk_bf16_f32 v160, v96, v97
    v_cvt_pk_bf16_f32 v161, v98, v99
    ds_write_b64 v5, v[160:161] offset:0
    v_pk_mul_f32 v[100:101], v[100:101], v[228:229] op_sel_hi:[1,0]
    v_pk_mul_f32 v[102:103], v[102:103], v[228:229] op_sel_hi:[1,0]
    v_cvt_pk_bf16_f32 v162, v100, v101
    v_cvt_pk_bf16_f32 v163, v102, v103
    ds_write_b64 v5, v[162:163] offset:7936
    v_pk_mul_f32 v[104:105], v[104:105], v[232:233] op_sel_hi:[1,0]
    v_pk_mul_f32 v[106:107], v[106:107], v[232:233] op_sel_hi:[1,0]
    v_cvt_pk_bf16_f32 v164, v104, v105
    v_cvt_pk_bf16_f32 v165, v106, v107
    ds_write_b64 v5, v[164:165] offset:15872
    v_pk_mul_f32 v[108:109], v[108:109], v[236:237] op_sel_hi:[1,0]
    v_pk_mul_f32 v[110:111], v[110:111], v[236:237] op_sel_hi:[1,0]
    v_cvt_pk_bf16_f32 v166, v108, v109
    v_cvt_pk_bf16_f32 v167, v110, v111
    ds_write_b64 v5, v[166:167] offset:23808
    v_pk_mul_f32 v[112:113], v[112:113], v[224:225] op_sel_hi:[1,0]
    v_pk_mul_f32 v[114:115], v[114:115], v[224:225] op_sel_hi:[1,0]
    v_cvt_pk_bf16_f32 v160, v112, v113
    v_cvt_pk_bf16_f32 v161, v114, v115
    ds_write_b64 v5, v[160:161] offset:8
    v_pk_mul_f32 v[116:117], v[116:117], v[228:229] op_sel_hi:[1,0]
    v_pk_mul_f32 v[118:119], v[118:119], v[228:229] op_sel_hi:[1,0]
    v_cvt_pk_bf16_f32 v162, v116, v117
    v_cvt_pk_bf16_f32 v163, v118, v119
    ds_write_b64 v5, v[162:163] offset:7944
    v_pk_mul_f32 v[120:121], v[120:121], v[232:233] op_sel_hi:[1,0]
    v_pk_mul_f32 v[122:123], v[122:123], v[232:233] op_sel_hi:[1,0]
    v_cvt_pk_bf16_f32 v164, v120, v121
    v_cvt_pk_bf16_f32 v165, v122, v123
    ds_write_b64 v5, v[164:165] offset:15880
    v_pk_mul_f32 v[124:125], v[124:125], v[236:237] op_sel_hi:[1,0]
    v_pk_mul_f32 v[126:127], v[126:127], v[236:237] op_sel_hi:[1,0]
    v_cvt_pk_bf16_f32 v166, v124, v125
    v_cvt_pk_bf16_f32 v167, v126, v127
    ds_write_b64 v5, v[166:167] offset:23816
    v_pk_mul_f32 v[128:129], v[128:129], v[224:225] op_sel_hi:[1,0]
    v_pk_mul_f32 v[130:131], v[130:131], v[224:225] op_sel_hi:[1,0]
    v_cvt_pk_bf16_f32 v160, v128, v129
    v_cvt_pk_bf16_f32 v161, v130, v131
    ds_write_b64 v4, v[160:161] offset:16
    v_pk_mul_f32 v[132:133], v[132:133], v[228:229] op_sel_hi:[1,0]
    v_pk_mul_f32 v[134:135], v[134:135], v[228:229] op_sel_hi:[1,0]
    v_cvt_pk_bf16_f32 v162, v132, v133
    v_cvt_pk_bf16_f32 v163, v134, v135
    ds_write_b64 v4, v[162:163] offset:7952
    v_mov_b32 v166, 0x3f80
    v_mov_b32 v167, 0
    ds_write_b64 v11, v[166:167] offset:480
    ds_write_b64 v11, v[166:167] offset:8416
    ds_write_b64 v11, v[166:167] offset:16352
    ds_write_b64 v11, v[166:167] offset:24288
    s_barrier
    s_lshl_b32 s53, s42, 3
    s_lshl_b32 s54, s50, 2
    s_add_u32 s53, s53, s54
    s_lshl_b32 s53, s53, 3
    s_add_u32 s53, s53, s45
    s_mul_i32 s53, s53, 2560
    s_add_u32 s53, s53, 16777216
    v_lshlrev_b32 v240, 4, v1
    v_add_u32 v240, s53, v240
    v_lshlrev_b32 v241, 3, v1
    v_add_u32 v241, s53, v241
    s_lshl_b32 s55, s50, 2
    s_add_u32 s55, s55, 1
    s_mul_i32 s53, s55, 2560
    s_add_u32 s53, s53, 65536
    v_lshlrev_b32 v13, 4, v1
    v_add_u32 v13, s53, v13
    v_lshlrev_b32 v14, 3, v1
    v_add_u32 v14, s53, v14
    ds_read_b128 v[144:147], v13
    ds_read_b128 v[148:151], v13 offset:1024
    ds_read_b64 v[152:153], v14 offset:2048
    v_mov_b32 v154, 0
    v_mov_b32 v155, 0
    v_mov_b32 v242, v228
    v_mul_u32_u24 v12, 80, v9
    v_add_u32 v12, v12, v11
    v_add_u32 v12, 7936, v12
    s_waitcnt lgkmcnt(0)
    v_bfe_u32 v13, v1, 2, 2
    v_and_b32 v14, 3, v1
    v_mul_u32_u24 v15, 800, v9
    v_pk_mul_f32 v[16:17], v[16:17], v[224:225] op_sel_hi:[1,0]
    v_mul_u32_u24 v13, 40, v13
    v_add_u32 v15, v15, v13
    v_pk_mul_f32 v[18:19], v[18:19], v[224:225] op_sel_hi:[1,0]
    v_add_u32 v15, 155648, v15
    v_mov_b32 v13, 159744
    v_cmp_eq_u32 vcc, v14, v9
    s_mov_b32 s57, 0x3fb8aa3b
    s_nop 0
    v_cndmask_b32 v15, v13, v15, vcc
    v_pk_mul_f32 v[32:33], v[32:33], v[224:225] op_sel_hi:[1,0]
    v_pk_mul_f32 v[34:35], v[34:35], v[224:225] op_sel_hi:[1,0]
    ds_read_b64_tr_b16 v[208:209], v15 offset:0
    ds_read_b64_tr_b16 v[210:211], v15 offset:160
    v_pk_mul_f32 v[48:49], v[48:49], v[224:225] op_sel_hi:[1,0]
    ds_read_b64_tr_b16 v[212:213], v15 offset:320
    ds_read_b64_tr_b16 v[214:215], v15 offset:480
    v_pk_mul_f32 v[50:51], v[50:51], v[224:225] op_sel_hi:[1,0]
    ds_read_b64_tr_b16 v[216:217], v15 offset:640
    v_mov_b32 v218, 0
    v_pk_mul_f32 v[64:65], v[64:65], v[224:225] op_sel_hi:[1,0]
    v_mov_b32 v219, 0
    ds_read_b64_tr_b16 v[220:221], v15 offset:8
    ds_read_b64_tr_b16 v[222:223], v15 offset:168
    v_pk_mul_f32 v[66:67], v[66:67], v[224:225] op_sel_hi:[1,0]
    s_waitcnt lgkmcnt(5)
    v_mfma_f32_16x16x32_bf16 v[96:99], v[208:211], v[144:147], 0
    v_pk_mul_f32 v[80:81], v[80:81], v[224:225] op_sel_hi:[1,0]
    ds_read_b64_tr_b16 v[208:209], v15 offset:328
    ds_read_b64_tr_b16 v[210:211], v15 offset:488
    s_waitcnt lgkmcnt(5)
    v_pk_mul_f32 v[82:83], v[82:83], v[224:225] op_sel_hi:[1,0]
    v_mfma_f32_16x16x32_bf16 v[96:99], v[212:215], v[148:151], v[96:99]
    ds_read_b64_tr_b16 v[212:213], v15 offset:648
    v_cvt_pk_bf16_f32 v176, v16, v17
    v_mov_b32 v214, 0
    v_mov_b32 v215, 0
    s_waitcnt lgkmcnt(5)
    v_cvt_pk_bf16_f32 v177, v18, v19
    s_nop 0
    v_mfma_f32_16x16x32_bf16 v[96:99], v[216:219], v[152:155], v[96:99]
    v_cvt_pk_bf16_f32 v178, v32, v33
    ds_read_b64_tr_b16 v[216:217], v15 offset:16
    ds_read_b64_tr_b16 v[218:219], v15 offset:176
    v_cvt_pk_bf16_f32 v179, v34, v35
    s_waitcnt lgkmcnt(5)
    v_mfma_f32_16x16x32_bf16 v[100:103], v[220:223], v[144:147], 0
    ds_read_b64_tr_b16 v[220:221], v15 offset:336
    v_cvt_pk_bf16_f32 v180, v48, v49
    ds_read_b64_tr_b16 v[222:223], v15 offset:496
    s_waitcnt lgkmcnt(5)
    v_cvt_pk_bf16_f32 v181, v50, v51
    v_mfma_f32_16x16x32_bf16 v[100:103], v[208:211], v[148:151], v[100:103]
    ds_read_b64_tr_b16 v[208:209], v15 offset:656
    v_mov_b32 v210, 0
    v_cvt_pk_bf16_f32 v182, v64, v65
    v_mov_b32 v211, 0
    s_waitcnt lgkmcnt(5)
    v_cvt_pk_bf16_f32 v183, v66, v67
    s_nop 0
    v_mfma_f32_16x16x32_bf16 v[100:103], v[212:215], v[152:155], v[100:103]
    ds_read_b64_tr_b16 v[212:213], v15 offset:24
    v_cvt_pk_bf16_f32 v184, v80, v81
    ds_read_b64_tr_b16 v[214:215], v15 offset:184
    s_waitcnt lgkmcnt(5)
    v_cvt_pk_bf16_f32 v185, v82, v83
    v_mfma_f32_16x16x32_bf16 v[104:107], v[216:219], v[144:147], 0
    ds_read_b64_tr_b16 v[216:217], v15 offset:344
    s_mov_b32 s54, 0
    ds_read_b64_tr_b16 v[218:219], v15 offset:504
    s_waitcnt lgkmcnt(5)
    v_mfma_f32_16x16x32_bf16 v[104:107], v[220:223], v[148:151], v[104:107]
    buffer_store_dwordx4 v[176:179], v240, s[24:27], s54 offen sc1
    ds_read_b64_tr_b16 v[220:221], v15 offset:664
    v_mov_b32 v222, 0
    buffer_store_dwordx4 v[180:183], v240, s[24:27], s54 offen offset:1024 sc1
    v_mov_b32 v223, 0
    s_waitcnt lgkmcnt(5)
    s_nop 0
    buffer_store_dwordx2 v[184:185], v241, s[24:27], s54 offen offset:2048 sc1
    v_mfma_f32_16x16x32_bf16 v[104:107], v[208:211], v[152:155], v[104:107]
    ds_read_b64_tr_b16 v[208:209], v15 offset:32
    v_pk_mul_f32 v[20:21], v[20:21], v[228:229] op_sel_hi:[1,0]
    ds_read_b64_tr_b16 v[210:211], v15 offset:192
    s_waitcnt lgkmcnt(5)
    v_mfma_f32_16x16x32_bf16 v[108:111], v[212:215], v[144:147], 0
    v_pk_mul_f32 v[22:23], v[22:23], v[228:229] op_sel_hi:[1,0]
    ds_read_b64_tr_b16 v[212:213], v15 offset:352
    ds_read_b64_tr_b16 v[214:215], v15 offset:512
    v_pk_mul_f32 v[36:37], v[36:37], v[228:229] op_sel_hi:[1,0]
    s_waitcnt lgkmcnt(5)
    v_mfma_f32_16x16x32_bf16 v[108:111], v[216:219], v[148:151], v[108:111]
    v_pk_mul_f32 v[38:39], v[38:39], v[228:229] op_sel_hi:[1,0]
    ds_read_b64_tr_b16 v[216:217], v15 offset:672
    v_mov_b32 v218, 0
    v_mov_b32 v219, 0
    v_pk_mul_f32 v[52:53], v[52:53], v[228:229] op_sel_hi:[1,0]
    s_waitcnt lgkmcnt(5)
    s_nop 0
    v_pk_mul_f32 v[54:55], v[54:55], v[228:229] op_sel_hi:[1,0]
    v_mfma_f32_16x16x32_bf16 v[108:111], v[220:223], v[152:155], v[108:111]
    s_waitcnt lgkmcnt(3)
    v_mfma_f32_16x16x32_bf16 v[112:115], v[208:211], v[144:147], 0
    v_pk_mul_f32 v[68:69], v[68:69], v[228:229] op_sel_hi:[1,0]
    s_waitcnt lgkmcnt(1)
    v_mfma_f32_16x16x32_bf16 v[112:115], v[212:215], v[148:151], v[112:115]
    v_pk_mul_f32 v[70:71], v[70:71], v[228:229] op_sel_hi:[1,0]
    s_waitcnt lgkmcnt(0)
    s_nop 0
    v_mfma_f32_16x16x32_bf16 v[112:115], v[216:219], v[152:155], v[112:115]
    v_pk_mul_f32 v[84:85], v[84:85], v[228:229] op_sel_hi:[1,0]
    s_nop 7
    v_max3_f32 v4, v96, v97, v98
    v_pk_mul_f32 v[86:87], v[86:87], v[228:229] op_sel_hi:[1,0]
    v_min3_f32 v5, v96, v97, v98
    v_max3_f32 v4, v4, v99, v100
    v_cvt_pk_bf16_f32 v188, v20, v21
    v_min3_f32 v5, v5, v99, v100
    v_max3_f32 v4, v4, v101, v102
    v_min3_f32 v5, v5, v101, v102
    v_cvt_pk_bf16_f32 v189, v22, v23
    v_max3_f32 v4, v4, v103, v104
    v_min3_f32 v5, v5, v103, v104
    v_cvt_pk_bf16_f32 v190, v36, v37
    v_max3_f32 v4, v4, v105, v106
    v_min3_f32 v5, v5, v105, v106
    v_max3_f32 v4, v4, v107, v108
    v_cvt_pk_bf16_f32 v191, v38, v39
    v_min3_f32 v5, v5, v107, v108
    v_max3_f32 v4, v4, v109, v110
    v_cvt_pk_bf16_f32 v192, v52, v53
    v_min3_f32 v5, v5, v109, v110
    v_max3_f32 v4, v4, v111, v112
    v_min3_f32 v5, v5, v111, v112
    v_cvt_pk_bf16_f32 v193, v54, v55
    v_max3_f32 v4, v4, v113, v114
    v_min3_f32 v5, v5, v113, v114
    v_cvt_pk_bf16_f32 v194, v68, v69
    v_max_f32 v4, v4, v115
    v_min_f32 v5, v5, v115
    v_cvt_pk_bf16_f32 v195, v70, v71
    v_mul_f32 v6, s57, v242
    v_mul_f32 v4, v4, v6
    v_mul_f32 v14, v5, v6
    v_cvt_pk_bf16_f32 v196, v84, v85
    v_pk_fma_f32 v[116:117], v[96:97], v[6:7], v[14:15] op_sel_hi:[1,0,0] neg_lo:[1,0,0] neg_hi:[1,0,0]
    v_pk_fma_f32 v[118:119], v[98:99], v[6:7], v[14:15] op_sel_hi:[1,0,0] neg_lo:[1,0,0] neg_hi:[1,0,0]
    v_cvt_pk_bf16_f32 v197, v86, v87
    v_pk_fma_f32 v[120:121], v[100:101], v[6:7], v[14:15] op_sel_hi:[1,0,0] neg_lo:[1,0,0] neg_hi:[1,0,0]
    v_pk_fma_f32 v[122:123], v[102:103], v[6:7], v[14:15] op_sel_hi:[1,0,0] neg_lo:[1,0,0] neg_hi:[1,0,0]
    v_pk_fma_f32 v[124:125], v[104:105], v[6:7], v[14:15] op_sel_hi:[1,0,0] neg_lo:[1,0,0] neg_hi:[1,0,0]
    s_mov_b32 s54, 20480
    v_pk_fma_f32 v[126:127], v[106:107], v[6:7], v[14:15] op_sel_hi:[1,0,0] neg_lo:[1,0,0] neg_hi:[1,0,0]
    v_pk_fma_f32 v[128:129], v[108:109], v[6:7], v[14:15] op_sel_hi:[1,0,0] neg_lo:[1,0,0] neg_hi:[1,0,0]
    buffer_store_dwordx4 v[188:191], v240, s[24:27], s54 offen sc1
    v_pk_fma_f32 v[130:131], v[110:111], v[6:7], v[14:15] op_sel_hi:[1,0,0] neg_lo:[1,0,0] neg_hi:[1,0,0]
    v_pk_fma_f32 v[132:133], v[112:113], v[6:7], v[14:15] op_sel_hi:[1,0,0] neg_lo:[1,0,0] neg_hi:[1,0,0]
    v_pk_fma_f32 v[134:135], v[114:115], v[6:7], v[14:15] op_sel_hi:[1,0,0] neg_lo:[1,0,0] neg_hi:[1,0,0]
    buffer_store_dwordx4 v[192:195], v240, s[24:27], s54 offen offset:1024 sc1
    v_pk_fma_f32 v[96:97], v[96:97], v[6:7], v[4:5] op_sel_hi:[1,0,0] neg_lo:[0,0,1] neg_hi:[0,0,1]
    v_pk_fma_f32 v[98:99], v[98:99], v[6:7], v[4:5] op_sel_hi:[1,0,0] neg_lo:[0,0,1] neg_hi:[0,0,1]
    buffer_store_dwordx2 v[196:197], v241, s[24:27], s54 offen offset:2048 sc1
    v_pk_fma_f32 v[100:101], v[100:101], v[6:7], v[4:5] op_sel_hi:[1,0,0] neg_lo:[0,0,1] neg_hi:[0,0,1]
    v_pk_fma_f32 v[102:103], v[102:103], v[6:7], v[4:5] op_sel_hi:[1,0,0] neg_lo:[0,0,1] neg_hi:[0,0,1]
    v_pk_mul_f32 v[24:25], v[24:25], v[232:233] op_sel_hi:[1,0]
    v_pk_fma_f32 v[104:105], v[104:105], v[6:7], v[4:5] op_sel_hi:[1,0,0] neg_lo:[0,0,1] neg_hi:[0,0,1]
    v_pk_fma_f32 v[106:107], v[106:107], v[6:7], v[4:5] op_sel_hi:[1,0,0] neg_lo:[0,0,1] neg_hi:[0,0,1]
    v_pk_fma_f32 v[108:109], v[108:109], v[6:7], v[4:5] op_sel_hi:[1,0,0] neg_lo:[0,0,1] neg_hi:[0,0,1]
    v_pk_mul_f32 v[26:27], v[26:27], v[232:233] op_sel_hi:[1,0]
    v_pk_fma_f32 v[110:111], v[110:111], v[6:7], v[4:5] op_sel_hi:[1,0,0] neg_lo:[0,0,1] neg_hi:[0,0,1]
    v_pk_fma_f32 v[112:113], v[112:113], v[6:7], v[4:5] op_sel_hi:[1,0,0] neg_lo:[0,0,1] neg_hi:[0,0,1]
    v_pk_mul_f32 v[40:41], v[40:41], v[232:233] op_sel_hi:[1,0]
    v_pk_fma_f32 v[114:115], v[114:115], v[6:7], v[4:5] op_sel_hi:[1,0,0] neg_lo:[0,0,1] neg_hi:[0,0,1]
    v_exp_f32 v116, v116
    v_exp_f32 v117, v117
    v_pk_mul_f32 v[42:43], v[42:43], v[232:233] op_sel_hi:[1,0]
    v_exp_f32 v118, v118
    v_exp_f32 v119, v119
    v_pk_mul_f32 v[56:57], v[56:57], v[232:233] op_sel_hi:[1,0]
    v_exp_f32 v120, v120
    v_exp_f32 v121, v121
    v_exp_f32 v122, v122
    v_pk_mul_f32 v[58:59], v[58:59], v[232:233] op_sel_hi:[1,0]
    v_exp_f32 v123, v123
    v_exp_f32 v124, v124
    v_pk_mul_f32 v[72:73], v[72:73], v[232:233] op_sel_hi:[1,0]
    v_exp_f32 v125, v125
    v_exp_f32 v126, v126
    v_pk_mul_f32 v[74:75], v[74:75], v[232:233] op_sel_hi:[1,0]
    v_exp_f32 v127, v127
    v_exp_f32 v128, v128
    v_exp_f32 v129, v129
    v_pk_mul_f32 v[88:89], v[88:89], v[232:233] op_sel_hi:[1,0]
    v_exp_f32 v130, v130
    v_exp_f32 v131, v131
    v_pk_mul_f32 v[90:91], v[90:91], v[232:233] op_sel_hi:[1,0]
    v_exp_f32 v132, v132
    v_exp_f32 v133, v133
    v_exp_f32 v134, v134
    v_cvt_pk_bf16_f32 v176, v24, v25
    v_exp_f32 v135, v135
    v_exp_f32 v96, v96
    v_cvt_pk_bf16_f32 v177, v26, v27
    v_exp_f32 v97, v97
    v_exp_f32 v98, v98
    v_exp_f32 v99, v99
    v_cvt_pk_bf16_f32 v178, v40, v41
    v_exp_f32 v100, v100
    v_exp_f32 v101, v101
    v_cvt_pk_bf16_f32 v179, v42, v43
    v_exp_f32 v102, v102
    v_exp_f32 v103, v103
    v_cvt_pk_bf16_f32 v180, v56, v57
    v_exp_f32 v104, v104
    v_exp_f32 v105, v105
    v_exp_f32 v106, v106
    v_cvt_pk_bf16_f32 v181, v58, v59
    v_exp_f32 v107, v107
    v_exp_f32 v108, v108
    v_cvt_pk_bf16_f32 v182, v72, v73
    v_exp_f32 v109, v109
    v_exp_f32 v110, v110
    v_exp_f32 v111, v111
    v_cvt_pk_bf16_f32 v183, v74, v75
    v_exp_f32 v112, v112
    v_exp_f32 v113, v113
    v_cvt_pk_bf16_f32 v184, v88, v89
    v_exp_f32 v114, v114
    v_exp_f32 v115, v115
    v_pk_add_f32 v[4:5], v[116:117], v[118:119]
    v_cvt_pk_bf16_f32 v185, v90, v91
    v_pk_add_f32 v[6:7], v[96:97], v[98:99]
    v_pk_add_f32 v[4:5], v[4:5], v[120:121]
    s_mov_b32 s54, 40960
    v_pk_add_f32 v[6:7], v[6:7], v[100:101]
    v_pk_add_f32 v[4:5], v[4:5], v[122:123]
    buffer_store_dwordx4 v[176:179], v240, s[24:27], s54 offen sc1
    v_pk_add_f32 v[6:7], v[6:7], v[102:103]
    v_pk_add_f32 v[4:5], v[4:5], v[124:125]
    v_pk_add_f32 v[6:7], v[6:7], v[104:105]
    buffer_store_dwordx4 v[180:183], v240, s[24:27], s54 offen offset:1024 sc1
    v_pk_add_f32 v[4:5], v[4:5], v[126:127]
    v_pk_add_f32 v[6:7], v[6:7], v[106:107]
    buffer_store_dwordx2 v[184:185], v241, s[24:27], s54 offen offset:2048 sc1
    v_pk_add_f32 v[4:5], v[4:5], v[128:129]
    v_pk_add_f32 v[6:7], v[6:7], v[108:109]
    v_pk_add_f32 v[4:5], v[4:5], v[130:131]
    v_pk_mul_f32 v[28:29], v[28:29], v[236:237] op_sel_hi:[1,0]
    v_pk_add_f32 v[6:7], v[6:7], v[110:111]
    v_pk_add_f32 v[4:5], v[4:5], v[132:133]
    v_pk_mul_f32 v[30:31], v[30:31], v[236:237] op_sel_hi:[1,0]
    v_pk_add_f32 v[6:7], v[6:7], v[112:113]
    v_pk_add_f32 v[4:5], v[4:5], v[134:135]
    v_pk_add_f32 v[6:7], v[6:7], v[114:115]
    v_pk_mul_f32 v[44:45], v[44:45], v[236:237] op_sel_hi:[1,0]
    v_add_f32 v4, v4, v5
    v_add_f32 v6, v6, v7
    v_pk_mul_f32 v[46:47], v[46:47], v[236:237] op_sel_hi:[1,0]
    v_rcp_f32 v4, v4
    v_rcp_f32 v6, v6
    v_pk_mul_f32 v[60:61], v[60:61], v[236:237] op_sel_hi:[1,0]
    s_nop 0
    v_pk_mul_f32 v[96:97], v[96:97], v[6:7] op_sel_hi:[1,0]
    v_pk_mul_f32 v[98:99], v[98:99], v[6:7] op_sel_hi:[1,0]
    v_pk_mul_f32 v[62:63], v[62:63], v[236:237] op_sel_hi:[1,0]
    v_pk_mul_f32 v[100:101], v[100:101], v[6:7] op_sel_hi:[1,0]
    v_pk_mul_f32 v[102:103], v[102:103], v[6:7] op_sel_hi:[1,0]
    v_pk_mul_f32 v[76:77], v[76:77], v[236:237] op_sel_hi:[1,0]
    v_pk_mul_f32 v[104:105], v[104:105], v[6:7] op_sel_hi:[1,0]
    v_pk_mul_f32 v[106:107], v[106:107], v[6:7] op_sel_hi:[1,0]
    v_pk_mul_f32 v[108:109], v[108:109], v[6:7] op_sel_hi:[1,0]
    v_pk_mul_f32 v[78:79], v[78:79], v[236:237] op_sel_hi:[1,0]
    v_pk_mul_f32 v[110:111], v[110:111], v[6:7] op_sel_hi:[1,0]
    v_pk_mul_f32 v[112:113], v[112:113], v[6:7] op_sel_hi:[1,0]
    v_pk_mul_f32 v[92:93], v[92:93], v[236:237] op_sel_hi:[1,0]
    v_pk_mul_f32 v[114:115], v[114:115], v[6:7] op_sel_hi:[1,0]
    v_pk_mul_f32 v[116:117], v[116:117], v[4:5] op_sel_hi:[1,0]
    v_pk_mul_f32 v[118:119], v[118:119], v[4:5] op_sel_hi:[1,0]
    v_pk_mul_f32 v[94:95], v[94:95], v[236:237] op_sel_hi:[1,0]
    v_pk_mul_f32 v[120:121], v[120:121], v[4:5] op_sel_hi:[1,0]
    v_pk_mul_f32 v[122:123], v[122:123], v[4:5] op_sel_hi:[1,0]
    v_cvt_pk_bf16_f32 v188, v28, v29
    v_pk_mul_f32 v[124:125], v[124:125], v[4:5] op_sel_hi:[1,0]
    v_pk_mul_f32 v[126:127], v[126:127], v[4:5] op_sel_hi:[1,0]
    v_cvt_pk_bf16_f32 v189, v30, v31
    v_pk_mul_f32 v[128:129], v[128:129], v[4:5] op_sel_hi:[1,0]
    v_pk_mul_f32 v[130:131], v[130:131], v[4:5] op_sel_hi:[1,0]
    v_pk_mul_f32 v[132:133], v[132:133], v[4:5] op_sel_hi:[1,0]
    v_cvt_pk_bf16_f32 v190, v44, v45
    v_pk_mul_f32 v[134:135], v[134:135], v[4:5] op_sel_hi:[1,0]
    v_cvt_pk_bf16_f32 v156, v96, v97
    v_cvt_pk_bf16_f32 v191, v46, v47
    v_cvt_pk_bf16_f32 v157, v98, v99
    v_cvt_pk_bf16_f32 v158, v100, v101
    v_cvt_pk_bf16_f32 v159, v102, v103
    v_cvt_pk_bf16_f32 v192, v60, v61
    v_cvt_pk_bf16_f32 v160, v104, v105
    v_cvt_pk_bf16_f32 v161, v106, v107
    v_cvt_pk_bf16_f32 v193, v62, v63
    v_cvt_pk_bf16_f32 v162, v108, v109
    v_cvt_pk_bf16_f32 v163, v110, v111
    v_cvt_pk_bf16_f32 v164, v112, v113
    v_cvt_pk_bf16_f32 v194, v76, v77
    v_cvt_pk_bf16_f32 v165, v114, v115
    v_cvt_pk_bf16_f32 v166, v116, v117
    v_cvt_pk_bf16_f32 v195, v78, v79
    v_cvt_pk_bf16_f32 v167, v118, v119
    v_cvt_pk_bf16_f32 v168, v120, v121
    v_cvt_pk_bf16_f32 v196, v92, v93
    v_cvt_pk_bf16_f32 v169, v122, v123
    v_cvt_pk_bf16_f32 v170, v124, v125
    v_cvt_pk_bf16_f32 v171, v126, v127
    v_cvt_pk_bf16_f32 v197, v94, v95
    v_cvt_pk_bf16_f32 v172, v128, v129
    v_cvt_pk_bf16_f32 v173, v130, v131
    s_mov_b32 s54, 61440
    v_cvt_pk_bf16_f32 v174, v132, v133
    v_cvt_pk_bf16_f32 v175, v134, v135
    ds_write_b128 v12, v[156:159] offset:0
    buffer_store_dwordx4 v[188:191], v240, s[24:27], s54 offen sc1
    ds_write_b128 v12, v[160:163] offset:16
    ds_write_b128 v12, v[164:167] offset:32
    buffer_store_dwordx4 v[192:195], v240, s[24:27], s54 offen offset:1024 sc1
    ds_write_b128 v12, v[168:171] offset:48
    ds_write_b128 v12, v[172:175] offset:64
    buffer_store_dwordx2 v[196:197], v241, s[24:27], s54 offen offset:2048 sc1
    s_branch k1_kernel_q_e3
k1_kernel_q_kw:
    s_nop 2
    s_lshl_b32 s55, s50, 2
    s_mul_i32 s53, s55, 2560
    s_add_u32 s53, s53, 65536
    v_lshlrev_b32 v13, 4, v1
    v_add_u32 v13, s53, v13
    v_lshlrev_b32 v14, 3, v1
    v_add_u32 v14, s53, v14
    v_cvt_pk_bf16_f32 v188, v20, v21
    v_cvt_pk_bf16_f32 v189, v22, v23
    v_cvt_pk_bf16_f32 v190, v36, v37
    v_cvt_pk_bf16_f32 v191, v38, v39
    v_cvt_pk_bf16_f32 v192, v52, v53
    v_cvt_pk_bf16_f32 v193, v54, v55
    v_cvt_pk_bf16_f32 v194, v68, v69
    v_cvt_pk_bf16_f32 v195, v70, v71
    v_cvt_pk_bf16_f32 v196, v84, v85
    v_cvt_pk_bf16_f32 v197, v86, v87
    ds_write_b128 v13, v[188:191] offset:2560
    ds_write_b128 v13, v[192:195] offset:3584
    ds_write_b64 v14, v[196:197] offset:4608
    v_cvt_pk_bf16_f32 v176, v24, v25
    v_cvt_pk_bf16_f32 v177, v26, v27
    v_cvt_pk_bf16_f32 v178, v40, v41
    v_cvt_pk_bf16_f32 v179, v42, v43
    v_cvt_pk_bf16_f32 v180, v56, v57
    v_cvt_pk_bf16_f32 v181, v58, v59
    v_cvt_pk_bf16_f32 v182, v72, v73
    v_cvt_pk_bf16_f32 v183, v74, v75
    v_cvt_pk_bf16_f32 v184, v88, v89
    v_cvt_pk_bf16_f32 v185, v90, v91
    ds_write_b128 v13, v[176:179] offset:5120
    ds_write_b128 v13, v[180:183] offset:6144
    ds_write_b64 v14, v[184:185] offset:7168
    v_cvt_pk_bf16_f32 v188, v28, v29
    v_cvt_pk_bf16_f32 v189, v30, v31
    v_cvt_pk_bf16_f32 v190, v44, v45
    v_cvt_pk_bf16_f32 v191, v46, v47
    v_cvt_pk_bf16_f32 v192, v60, v61
    v_cvt_pk_bf16_f32 v193, v62, v63
    v_cvt_pk_bf16_f32 v194, v76, v77
    v_cvt_pk_bf16_f32 v195, v78, v79
    v_cvt_pk_bf16_f32 v196, v92, v93
    v_cvt_pk_bf16_f32 v197, v94, v95
    ds_write_b128 v13, v[188:191] offset:7680
    ds_write_b128 v13, v[192:195] offset:8704
    ds_write_b64 v14, v[196:197] offset:9728
    v_cvt_pk_bf16_f32 v144, v16, v17
    v_cvt_pk_bf16_f32 v145, v18, v19
    v_cvt_pk_bf16_f32 v146, v32, v33
    v_cvt_pk_bf16_f32 v147, v34, v35
    v_cvt_pk_bf16_f32 v148, v48, v49
    v_cvt_pk_bf16_f32 v149, v50, v51
    v_cvt_pk_bf16_f32 v150, v64, v65
    v_cvt_pk_bf16_f32 v151, v66, v67
    v_cvt_pk_bf16_f32 v152, v80, v81
    v_cvt_pk_bf16_f32 v153, v82, v83
    v_mov_b32 v154, 0
    v_mov_b32 v155, 0
    v_mov_b32 v168, v224
    v_mul_u32_u24 v12, 80, v9
    v_add_u32 v12, v12, v11
    s_waitcnt lgkmcnt(0)
    s_barrier
    v_bfe_u32 v13, v1, 2, 2
    v_and_b32 v14, 3, v1
    v_mul_u32_u24 v15, 800, v9
    v_mul_u32_u24 v13, 40, v13
    v_add_u32 v15, v15, v13
    v_add_u32 v15, 155648, v15
    v_mov_b32 v13, 159744
    v_cmp_eq_u32 vcc, v14, v9
    s_mov_b32 s57, 0x3fb8aa3b
    s_nop 0
    v_cndmask_b32 v15, v13, v15, vcc
    ds_read_b64_tr_b16 v[208:209], v15 offset:0
    ds_read_b64_tr_b16 v[210:211], v15 offset:160
    ds_read_b64_tr_b16 v[212:213], v15 offset:320
    ds_read_b64_tr_b16 v[214:215], v15 offset:480
    ds_read_b64_tr_b16 v[216:217], v15 offset:640
    v_mov_b32 v218, 0
    v_mov_b32 v219, 0
    ds_read_b64_tr_b16 v[220:221], v15 offset:8
    ds_read_b64_tr_b16 v[222:223], v15 offset:168
    s_waitcnt lgkmcnt(5)
    v_mfma_f32_16x16x32_bf16 v[16:19], v[208:211], v[144:147], 0
    ds_read_b64_tr_b16 v[208:209], v15 offset:328
    ds_read_b64_tr_b16 v[210:211], v15 offset:488
    s_waitcnt lgkmcnt(5)
    v_mfma_f32_16x16x32_bf16 v[16:19], v[212:215], v[148:151], v[16:19]
    ds_read_b64_tr_b16 v[212:213], v15 offset:648
    v_mov_b32 v214, 0
    v_mov_b32 v215, 0
    s_waitcnt lgkmcnt(5)
    s_nop 0
    v_mfma_f32_16x16x32_bf16 v[16:19], v[216:219], v[152:155], v[16:19]
    ds_read_b64_tr_b16 v[216:217], v15 offset:16
    ds_read_b64_tr_b16 v[218:219], v15 offset:176
    s_waitcnt lgkmcnt(5)
    v_mfma_f32_16x16x32_bf16 v[20:23], v[220:223], v[144:147], 0
    ds_read_b64_tr_b16 v[220:221], v15 offset:336
    ds_read_b64_tr_b16 v[222:223], v15 offset:496
    s_waitcnt lgkmcnt(5)
    v_mfma_f32_16x16x32_bf16 v[20:23], v[208:211], v[148:151], v[20:23]
    ds_read_b64_tr_b16 v[208:209], v15 offset:656
    v_mov_b32 v210, 0
    v_mov_b32 v211, 0
    s_waitcnt lgkmcnt(5)
    s_nop 0
    v_mfma_f32_16x16x32_bf16 v[20:23], v[212:215], v[152:155], v[20:23]
    ds_read_b64_tr_b16 v[212:213], v15 offset:24
    ds_read_b64_tr_b16 v[214:215], v15 offset:184
    s_waitcnt lgkmcnt(5)
    v_mfma_f32_16x16x32_bf16 v[24:27], v[216:219], v[144:147], 0
    ds_read_b64_tr_b16 v[216:217], v15 offset:344
    ds_read_b64_tr_b16 v[218:219], v15 offset:504
    s_waitcnt lgkmcnt(5)
    v_mfma_f32_16x16x32_bf16 v[24:27], v[220:223], v[148:151], v[24:27]
    ds_read_b64_tr_b16 v[220:221], v15 offset:664
    v_mov_b32 v222, 0
    v_mov_b32 v223, 0
    s_waitcnt lgkmcnt(5)
    s_nop 0
    v_mfma_f32_16x16x32_bf16 v[24:27], v[208:211], v[152:155], v[24:27]
    ds_read_b64_tr_b16 v[208:209], v15 offset:32
    ds_read_b64_tr_b16 v[210:211], v15 offset:192
    s_waitcnt lgkmcnt(5)
    v_mfma_f32_16x16x32_bf16 v[28:31], v[212:215], v[144:147], 0
    ds_read_b64_tr_b16 v[212:213], v15 offset:352
    ds_read_b64_tr_b16 v[214:215], v15 offset:512
    s_waitcnt lgkmcnt(5)
    v_mfma_f32_16x16x32_bf16 v[28:31], v[216:219], v[148:151], v[28:31]
    ds_read_b64_tr_b16 v[216:217], v15 offset:672
    v_mov_b32 v218, 0
    v_mov_b32 v219, 0
    s_waitcnt lgkmcnt(5)
    s_nop 0
    v_mfma_f32_16x16x32_bf16 v[28:31], v[220:223], v[152:155], v[28:31]
    s_waitcnt lgkmcnt(3)
    v_mfma_f32_16x16x32_bf16 v[32:35], v[208:211], v[144:147], 0
    s_waitcnt lgkmcnt(1)
    v_mfma_f32_16x16x32_bf16 v[32:35], v[212:215], v[148:151], v[32:35]
    s_waitcnt lgkmcnt(0)
    s_nop 0
    v_mfma_f32_16x16x32_bf16 v[32:35], v[216:219], v[152:155], v[32:35]
    s_nop 7
    v_max3_f32 v4, v16, v17, v18
    v_min3_f32 v5, v16, v17, v18
    v_max3_f32 v4, v4, v19, v20
    v_min3_f32 v5, v5, v19, v20
    v_max3_f32 v4, v4, v21, v22
    v_min3_f32 v5, v5, v21, v22
    v_max3_f32 v4, v4, v23, v24
    v_min3_f32 v5, v5, v23, v24
    v_max3_f32 v4, v4, v25, v26
    v_min3_f32 v5, v5, v25, v26
    v_max3_f32 v4, v4, v27, v28
    v_min3_f32 v5, v5, v27, v28
    v_max3_f32 v4, v4, v29, v30
    v_min3_f32 v5, v5, v29, v30
    v_max3_f32 v4, v4, v31, v32
    v_min3_f32 v5, v5, v31, v32
    v_max3_f32 v4, v4, v33, v34
    v_min3_f32 v5, v5, v33, v34
    v_max_f32 v4, v4, v35
    v_min_f32 v5, v5, v35
    v_mul_f32 v6, s57, v168
    v_mul_f32 v4, v4, v6
    v_mul_f32 v14, v5, v6
    v_pk_fma_f32 v[56:57], v[16:17], v[6:7], v[14:15] op_sel_hi:[1,0,0] neg_lo:[1,0,0] neg_hi:[1,0,0]
    v_pk_fma_f32 v[58:59], v[18:19], v[6:7], v[14:15] op_sel_hi:[1,0,0] neg_lo:[1,0,0] neg_hi:[1,0,0]
    v_pk_fma_f32 v[60:61], v[20:21], v[6:7], v[14:15] op_sel_hi:[1,0,0] neg_lo:[1,0,0] neg_hi:[1,0,0]
    v_pk_fma_f32 v[62:63], v[22:23], v[6:7], v[14:15] op_sel_hi:[1,0,0] neg_lo:[1,0,0] neg_hi:[1,0,0]
    v_pk_fma_f32 v[64:65], v[24:25], v[6:7], v[14:15] op_sel_hi:[1,0,0] neg_lo:[1,0,0] neg_hi:[1,0,0]
    v_pk_fma_f32 v[66:67], v[26:27], v[6:7], v[14:15] op_sel_hi:[1,0,0] neg_lo:[1,0,0] neg_hi:[1,0,0]
    v_pk_fma_f32 v[68:69], v[28:29], v[6:7], v[14:15] op_sel_hi:[1,0,0] neg_lo:[1,0,0] neg_hi:[1,0,0]
    v_pk_fma_f32 v[70:71], v[30:31], v[6:7], v[14:15] op_sel_hi:[1,0,0] neg_lo:[1,0,0] neg_hi:[1,0,0]
    v_pk_fma_f32 v[72:73], v[32:33], v[6:7], v[14:15] op_sel_hi:[1,0,0] neg_lo:[1,0,0] neg_hi:[1,0,0]
    v_pk_fma_f32 v[74:75], v[34:35], v[6:7], v[14:15] op_sel_hi:[1,0,0] neg_lo:[1,0,0] neg_hi:[1,0,0]
    v_pk_fma_f32 v[16:17], v[16:17], v[6:7], v[4:5] op_sel_hi:[1,0,0] neg_lo:[0,0,1] neg_hi:[0,0,1]
    v_pk_fma_f32 v[18:19], v[18:19], v[6:7], v[4:5] op_sel_hi:[1,0,0] neg_lo:[0,0,1] neg_hi:[0,0,1]
    v_pk_fma_f32 v[20:21], v[20:21], v[6:7], v[4:5] op_sel_hi:[1,0,0] neg_lo:[0,0,1] neg_hi:[0,0,1]
    v_pk_fma_f32 v[22:23], v[22:23], v[6:7], v[4:5] op_sel_hi:[1,0,0] neg_lo:[0,0,1] neg_hi:[0,0,1]
    v_pk_fma_f32 v[24:25], v[24:25], v[6:7], v[4:5] op_sel_hi:[1,0,0] neg_lo:[0,0,1] neg_hi:[0,0,1]
    v_pk_fma_f32 v[26:27], v[26:27], v[6:7], v[4:5] op_sel_hi:[1,0,0] neg_lo:[0,0,1] neg_hi:[0,0,1]
    v_pk_fma_f32 v[28:29], v[28:29], v[6:7], v[4:5] op_sel_hi:[1,0,0] neg_lo:[0,0,1] neg_hi:[0,0,1]
    v_pk_fma_f32 v[30:31], v[30:31], v[6:7], v[4:5] op_sel_hi:[1,0,0] neg_lo:[0,0,1] neg_hi:[0,0,1]
    v_pk_fma_f32 v[32:33], v[32:33], v[6:7], v[4:5] op_sel_hi:[1,0,0] neg_lo:[0,0,1] neg_hi:[0,0,1]
    v_pk_fma_f32 v[34:35], v[34:35], v[6:7], v[4:5] op_sel_hi:[1,0,0] neg_lo:[0,0,1] neg_hi:[0,0,1]
    v_exp_f32 v56, v56
    v_exp_f32 v57, v57
    v_exp_f32 v58, v58
    v_exp_f32 v59, v59
    v_exp_f32 v60, v60
    v_exp_f32 v61, v61
    v_exp_f32 v62, v62
    v_exp_f32 v63, v63
    v_exp_f32 v64, v64
    v_exp_f32 v65, v65
    v_exp_f32 v66, v66
    v_exp_f32 v67, v67
    v_exp_f32 v68, v68
    v_exp_f32 v69, v69
    v_exp_f32 v70, v70
    v_exp_f32 v71, v71
    v_exp_f32 v72, v72
    v_exp_f32 v73, v73
    v_exp_f32 v74, v74
    v_exp_f32 v75, v75
    v_exp_f32 v16, v16
    v_exp_f32 v17, v17
    v_exp_f32 v18, v18
    v_exp_f32 v19, v19
    v_exp_f32 v20, v20
    v_exp_f32 v21, v21
    v_exp_f32 v22, v22
    v_exp_f32 v23, v23
    v_exp_f32 v24, v24
    v_exp_f32 v25, v25
    v_exp_f32 v26, v26
    v_exp_f32 v27, v27
    v_exp_f32 v28, v28
    v_exp_f32 v29, v29
    v_exp_f32 v30, v30
    v_exp_f32 v31, v31
    v_exp_f32 v32, v32
    v_exp_f32 v33, v33
    v_exp_f32 v34, v34
    v_exp_f32 v35, v35
    v_pk_add_f32 v[4:5], v[56:57], v[58:59]
    v_pk_add_f32 v[6:7], v[16:17], v[18:19]
    v_pk_add_f32 v[4:5], v[4:5], v[60:61]
    v_pk_add_f32 v[6:7], v[6:7], v[20:21]
    v_pk_add_f32 v[4:5], v[4:5], v[62:63]
    v_pk_add_f32 v[6:7], v[6:7], v[22:23]
    v_pk_add_f32 v[4:5], v[4:5], v[64:65]
    v_pk_add_f32 v[6:7], v[6:7], v[24:25]
    v_pk_add_f32 v[4:5], v[4:5], v[66:67]
    v_pk_add_f32 v[6:7], v[6:7], v[26:27]
    v_pk_add_f32 v[4:5], v[4:5], v[68:69]
    v_pk_add_f32 v[6:7], v[6:7], v[28:29]
    v_pk_add_f32 v[4:5], v[4:5], v[70:71]
    v_pk_add_f32 v[6:7], v[6:7], v[30:31]
    v_pk_add_f32 v[4:5], v[4:5], v[72:73]
    v_pk_add_f32 v[6:7], v[6:7], v[32:33]
    v_pk_add_f32 v[4:5], v[4:5], v[74:75]
    v_pk_add_f32 v[6:7], v[6:7], v[34:35]
    v_add_f32 v4, v4, v5
    v_add_f32 v6, v6, v7
    v_rcp_f32 v4, v4
    v_rcp_f32 v6, v6
    s_nop 0
    v_pk_mul_f32 v[16:17], v[16:17], v[6:7] op_sel_hi:[1,0]
    v_pk_mul_f32 v[18:19], v[18:19], v[6:7] op_sel_hi:[1,0]
    v_pk_mul_f32 v[20:21], v[20:21], v[6:7] op_sel_hi:[1,0]
    v_pk_mul_f32 v[22:23], v[22:23], v[6:7] op_sel_hi:[1,0]
    v_pk_mul_f32 v[24:25], v[24:25], v[6:7] op_sel_hi:[1,0]
    v_pk_mul_f32 v[26:27], v[26:27], v[6:7] op_sel_hi:[1,0]
    v_pk_mul_f32 v[28:29], v[28:29], v[6:7] op_sel_hi:[1,0]
    v_pk_mul_f32 v[30:31], v[30:31], v[6:7] op_sel_hi:[1,0]
    v_pk_mul_f32 v[32:33], v[32:33], v[6:7] op_sel_hi:[1,0]
    v_pk_mul_f32 v[34:35], v[34:35], v[6:7] op_sel_hi:[1,0]
    v_pk_mul_f32 v[56:57], v[56:57], v[4:5] op_sel_hi:[1,0]
    v_pk_mul_f32 v[58:59], v[58:59], v[4:5] op_sel_hi:[1,0]
    v_pk_mul_f32 v[60:61], v[60:61], v[4:5] op_sel_hi:[1,0]
    v_pk_mul_f32 v[62:63], v[62:63], v[4:5] op_sel_hi:[1,0]
    v_pk_mul_f32 v[64:65], v[64:65], v[4:5] op_sel_hi:[1,0]
    v_pk_mul_f32 v[66:67], v[66:67], v[4:5] op_sel_hi:[1,0]
    v_pk_mul_f32 v[68:69], v[68:69], v[4:5] op_sel_hi:[1,0]
    v_pk_mul_f32 v[70:71], v[70:71], v[4:5] op_sel_hi:[1,0]
    v_pk_mul_f32 v[72:73], v[72:73], v[4:5] op_sel_hi:[1,0]
    v_pk_mul_f32 v[74:75], v[74:75], v[4:5] op_sel_hi:[1,0]
    v_cvt_pk_bf16_f32 v36, v16, v17
    v_cvt_pk_bf16_f32 v37, v18, v19
    v_cvt_pk_bf16_f32 v38, v20, v21
    v_cvt_pk_bf16_f32 v39, v22, v23
    v_cvt_pk_bf16_f32 v40, v24, v25
    v_cvt_pk_bf16_f32 v41, v26, v27
    v_cvt_pk_bf16_f32 v42, v28, v29
    v_cvt_pk_bf16_f32 v43, v30, v31
    v_cvt_pk_bf16_f32 v44, v32, v33
    v_cvt_pk_bf16_f32 v45, v34, v35
    v_cvt_pk_bf16_f32 v46, v56, v57
    v_cvt_pk_bf16_f32 v47, v58, v59
    v_cvt_pk_bf16_f32 v48, v60, v61
    v_cvt_pk_bf16_f32 v49, v62, v63
    v_cvt_pk_bf16_f32 v50, v64, v65
    v_cvt_pk_bf16_f32 v51, v66, v67
    v_cvt_pk_bf16_f32 v52, v68, v69
    v_cvt_pk_bf16_f32 v53, v70, v71
    v_cvt_pk_bf16_f32 v54, v72, v73
    v_cvt_pk_bf16_f32 v55, v74, v75
    ds_write_b128 v12, v[36:39] offset:0
    ds_write_b128 v12, v[40:43] offset:16
    ds_write_b128 v12, v[44:47] offset:32
    ds_write_b128 v12, v[48:51] offset:48
    ds_write_b128 v12, v[52:55] offset:64
    v_mul_u32_u24 v4, 40, v9
    v_add_u32 v4, v4, v11
    v_add_u32 v4, 320, v4
    s_mul_i32 s53, s51, 24
    v_add_u32 v5, s53, v4
    v_pk_mul_f32 v[96:97], v[96:97], v[224:225] op_sel_hi:[1,0]
    v_pk_mul_f32 v[98:99], v[98:99], v[224:225] op_sel_hi:[1,0]
    v_cvt_pk_bf16_f32 v160, v96, v97
    v_cvt_pk_bf16_f32 v161, v98, v99
    ds_write_b64 v5, v[160:161] offset:0
    v_pk_mul_f32 v[100:101], v[100:101], v[228:229] op_sel_hi:[1,0]
    v_pk_mul_f32 v[102:103], v[102:103], v[228:229] op_sel_hi:[1,0]
    v_cvt_pk_bf16_f32 v162, v100, v101
    v_cvt_pk_bf16_f32 v163, v102, v103
    ds_write_b64 v5, v[162:163] offset:7936
    v_pk_mul_f32 v[104:105], v[104:105], v[232:233] op_sel_hi:[1,0]
    v_pk_mul_f32 v[106:107], v[106:107], v[232:233] op_sel_hi:[1,0]
    v_cvt_pk_bf16_f32 v164, v104, v105
    v_cvt_pk_bf16_f32 v165, v106, v107
    ds_write_b64 v5, v[164:165] offset:15872
    v_pk_mul_f32 v[108:109], v[108:109], v[236:237] op_sel_hi:[1,0]
    v_pk_mul_f32 v[110:111], v[110:111], v[236:237] op_sel_hi:[1,0]
    v_cvt_pk_bf16_f32 v166, v108, v109
    v_cvt_pk_bf16_f32 v167, v110, v111
    ds_write_b64 v5, v[166:167] offset:23808
    v_pk_mul_f32 v[112:113], v[112:113], v[224:225] op_sel_hi:[1,0]
    v_pk_mul_f32 v[114:115], v[114:115], v[224:225] op_sel_hi:[1,0]
    v_cvt_pk_bf16_f32 v160, v112, v113
    v_cvt_pk_bf16_f32 v161, v114, v115
    ds_write_b64 v5, v[160:161] offset:8
    v_pk_mul_f32 v[116:117], v[116:117], v[228:229] op_sel_hi:[1,0]
    v_pk_mul_f32 v[118:119], v[118:119], v[228:229] op_sel_hi:[1,0]
    v_cvt_pk_bf16_f32 v162, v116, v117
    v_cvt_pk_bf16_f32 v163, v118, v119
    ds_write_b64 v5, v[162:163] offset:7944
    v_pk_mul_f32 v[120:121], v[120:121], v[232:233] op_sel_hi:[1,0]
    v_pk_mul_f32 v[122:123], v[122:123], v[232:233] op_sel_hi:[1,0]
    v_cvt_pk_bf16_f32 v164, v120, v121
    v_cvt_pk_bf16_f32 v165, v122, v123
    ds_write_b64 v5, v[164:165] offset:15880
    v_pk_mul_f32 v[124:125], v[124:125], v[236:237] op_sel_hi:[1,0]
    v_pk_mul_f32 v[126:127], v[126:127], v[236:237] op_sel_hi:[1,0]
    v_cvt_pk_bf16_f32 v166, v124, v125
    v_cvt_pk_bf16_f32 v167, v126, v127
    ds_write_b64 v5, v[166:167] offset:23816
    v_pk_mul_f32 v[128:129], v[128:129], v[232:233] op_sel_hi:[1,0]
    v_pk_mul_f32 v[130:131], v[130:131], v[232:233] op_sel_hi:[1,0]
    v_cvt_pk_bf16_f32 v160, v128, v129
    v_cvt_pk_bf16_f32 v161, v130, v131
    ds_write_b64 v4, v[160:161] offset:15888
    v_pk_mul_f32 v[132:133], v[132:133], v[236:237] op_sel_hi:[1,0]
    v_pk_mul_f32 v[134:135], v[134:135], v[236:237] op_sel_hi:[1,0]
    v_cvt_pk_bf16_f32 v162, v132, v133
    v_cvt_pk_bf16_f32 v163, v134, v135
    ds_write_b64 v4, v[162:163] offset:23824
k1_kernel_q_e3:
    s_waitcnt lgkmcnt(0)
    s_barrier
    v_and_b32 v8, 15, v1
    v_lshrrev_b32 v9, 4, v1
    s_lshr_b32 s52, s40, 1
    s_and_b32 s53, s40, 1
    v_bfe_u32 v13, v1, 2, 2
    v_and_b32 v14, 3, v1
    v_lshl_add_u32 v13, v9, 3, v13
    v_mul_u32_u24 v13, 496, v13
    s_mul_i32 s54, s52, 40
    s_add_u32 s54, s54, 320
    v_lshl_add_u32 v15, v14, 3, s54
    s_add_u32 s54, s54, 32
    v_mov_b32 v2, 480
    v_mov_b32 v3, s54
    v_cmp_eq_u32 vcc, 0, v14
    s_nop 1
    v_cndmask_b32 v2, v2, v3, vcc
    s_cmp_eq_u32 s53, 0
    s_cselect_b64 vcc, -1, 0
    s_nop 1
    v_cndmask_b32 v15, v2, v15, vcc
    v_add_u32 v2, v13, v15
    s_mul_i32 s54, s52, 80
    v_lshl_add_u32 v3, v14, 3, s54
    v_add_u32 v3, v3, v13
    v_and_b32 v4, 1, v14
    v_lshl_add_u32 v4, v4, 3, s54
    v_add3_u32 v4, v4, v13, 64
    ds_read_b64_tr_b16 v[32:33], v2 offset:0
    ds_read_b64_tr_b16 v[34:35], v2 offset:1984
    ds_read_b64_tr_b16 v[36:37], v3 offset:0
    ds_read_b64_tr_b16 v[38:39], v3 offset:1984
    ds_read_b64_tr_b16 v[40:41], v3 offset:32
    ds_read_b64_tr_b16 v[42:43], v3 offset:2016
    ds_read_b64_tr_b16 v[44:45], v4 offset:0
    ds_read_b64_tr_b16 v[46:47], v4 offset:1984
    ds_read_b64_tr_b16 v[48:49], v2 offset:15872
    ds_read_b64_tr_b16 v[50:51], v2 offset:17856
    ds_read_b64_tr_b16 v[52:53], v3 offset:15872
    ds_read_b64_tr_b16 v[54:55], v3 offset:17856
    ds_read_b64_tr_b16 v[56:57], v3 offset:15904
    ds_read_b64_tr_b16 v[58:59], v3 offset:17888
    ds_read_b64_tr_b16 v[60:61], v4 offset:15872
    ds_read_b64_tr_b16 v[62:63], v4 offset:17856
    s_waitcnt lgkmcnt(8)
    ds_read_b64_tr_b16 v[64:65], v2 offset:31744
    ds_read_b64_tr_b16 v[66:67], v2 offset:33728
    ds_read_b64_tr_b16 v[68:69], v3 offset:31744
    ds_read_b64_tr_b16 v[70:71], v3 offset:33728
    ds_read_b64_tr_b16 v[72:73], v3 offset:31776
    ds_read_b64_tr_b16 v[74:75], v3 offset:33760
    ds_read_b64_tr_b16 v[76:77], v4 offset:31744
    ds_read_b64_tr_b16 v[78:79], v4 offset:33728
    v_mfma_f32_16x16x32_bf16 v[16:19], v[32:35], v[36:39], 0
    v_mfma_f32_16x16x32_bf16 v[20:23], v[32:35], v[40:43], 0
    v_mfma_f32_16x16x32_bf16 v[24:27], v[32:35], v[44:47], 0
    s_waitcnt lgkmcnt(8)
    ds_read_b64_tr_b16 v[80:81], v2 offset:47616
    ds_read_b64_tr_b16 v[82:83], v2 offset:49600
    ds_read_b64_tr_b16 v[84:85], v3 offset:47616
    ds_read_b64_tr_b16 v[86:87], v3 offset:49600
    ds_read_b64_tr_b16 v[88:89], v3 offset:47648
    ds_read_b64_tr_b16 v[90:91], v3 offset:49632
    ds_read_b64_tr_b16 v[92:93], v4 offset:47616
    ds_read_b64_tr_b16 v[94:95], v4 offset:49600
    v_mfma_f32_16x16x32_bf16 v[16:19], v[48:51], v[52:55], v[16:19]
    v_mfma_f32_16x16x32_bf16 v[20:23], v[48:51], v[56:59], v[20:23]
    v_mfma_f32_16x16x32_bf16 v[24:27], v[48:51], v[60:63], v[24:27]
    s_waitcnt lgkmcnt(8)
    v_mfma_f32_16x16x32_bf16 v[16:19], v[64:67], v[68:71], v[16:19]
    v_mfma_f32_16x16x32_bf16 v[20:23], v[64:67], v[72:75], v[20:23]
    v_mfma_f32_16x16x32_bf16 v[24:27], v[64:67], v[76:79], v[24:27]
    s_waitcnt lgkmcnt(0)
    v_mfma_f32_16x16x32_bf16 v[16:19], v[80:83], v[84:87], v[16:19]
    v_mfma_f32_16x16x32_bf16 v[20:23], v[80:83], v[88:91], v[20:23]
    v_mfma_f32_16x16x32_bf16 v[24:27], v[80:83], v[92:95], v[24:27]
    s_lshl_b32 s54, s42, 5
    s_lshl_b32 s55, s45, 2
    s_add_u32 s54, s54, s55
    s_add_u32 s54, s54, s52
    s_mul_i32 s54, s54, 3840
    s_mul_i32 s55, s53, 2560
    s_add_u32 s54, s54, s55
    s_add_u32 s54, s54, 25165824
    v_mul_u32_u24 v13, 640, v9
    v_lshl_add_u32 v13, v8, 2, v13
    v_add_u32 v13, s54, v13
    v_mov_b32 v14, 2146435072
    v_cmp_gt_u32 vcc, 2, v9
    s_cmp_eq_u32 s53, 0
    s_cselect_b64 s[56:57], -1, 0
    s_nop 1
    s_or_b64 vcc, vcc, s[56:57]
    s_nop 1
    v_cndmask_b32 v13, v14, v13, vcc
    v_cmp_gt_u32 vcc, 8, v8
    s_nop 1
    v_cndmask_b32 v15, v14, v13, vcc
    s_nop 3
    buffer_store_dword v16, v13, s[24:27], 0 offen offset:0
    buffer_store_dword v17, v13, s[24:27], 0 offen offset:160
    buffer_store_dword v18, v13, s[24:27], 0 offen offset:320
    buffer_store_dword v19, v13, s[24:27], 0 offen offset:480
    buffer_store_dword v20, v13, s[24:27], 0 offen offset:64
    buffer_store_dword v21, v13, s[24:27], 0 offen offset:224
    buffer_store_dword v22, v13, s[24:27], 0 offen offset:384
    buffer_store_dword v23, v13, s[24:27], 0 offen offset:544
    buffer_store_dword v24, v15, s[24:27], 0 offen offset:128
    buffer_store_dword v25, v15, s[24:27], 0 offen offset:288
    buffer_store_dword v26, v15, s[24:27], 0 offen offset:448
    buffer_store_dword v27, v15, s[24:27], 0 offen offset:608
    s_waitcnt vmcnt(0)
    s_endpgm
k1_kernel_idle:
    s_cmp_ge_u32 s2, 256
    s_cbranch_scc0 k1_kernel_id1
    s_endpgm
k1_kernel_id1:
    s_cmp_lt_u32 s40, 4
    s_cbranch_scc1 k1_kernel_id4
    s_cmp_eq_u32 s2, 255
    s_cbranch_scc0 k1_kernel_idpf
    s_waitcnt lgkmcnt(0)
    v_lshlrev_b32 v3, 8, v1
    v_add_u32 v3, 29687808, v3
    v_mov_b32 v4, 0
    global_store_dword v3, v4, s[10:11]
    s_waitcnt vmcnt(0)
    s_branch k1_kernel_idpf
k1_kernel_id4:
    s_cmp_lt_u32 s2, 228
    s_cbranch_scc0 k1_kernel_idpf
    s_waitcnt vmcnt(0)
    v_mov_b32 v196, 0
    v_mov_b32 v197, 0
    s_mov_b32 s70, 0x3f803f80
    s_waitcnt vmcnt(63)
    v_dot2_f32_bf16 v196, v156, s70, v196
    v_dot2_f32_bf16 v197, v156, v156, v197
    v_dot2_f32_bf16 v196, v157, s70, v196
    v_dot2_f32_bf16 v197, v157, v157, v197
    v_dot2_f32_bf16 v196, v158, s70, v196
    v_dot2_f32_bf16 v197, v158, v158, v197
    v_dot2_f32_bf16 v196, v159, s70, v196
    v_dot2_f32_bf16 v197, v159, v159, v197
    v_dot2_f32_bf16 v196, v160, s70, v196
    v_dot2_f32_bf16 v197, v160, v160, v197
    v_dot2_f32_bf16 v196, v161, s70, v196
    v_dot2_f32_bf16 v197, v161, v161, v197
    v_dot2_f32_bf16 v196, v162, s70, v196
    v_dot2_f32_bf16 v197, v162, v162, v197
    v_dot2_f32_bf16 v196, v163, s70, v196
    v_dot2_f32_bf16 v197, v163, v163, v197
    v_dot2_f32_bf16 v196, v164, s70, v196
    v_dot2_f32_bf16 v197, v164, v164, v197
    v_dot2_f32_bf16 v196, v165, s70, v196
    v_dot2_f32_bf16 v197, v165, v165, v197
    v_dot2_f32_bf16 v196, v166, s70, v196
    v_dot2_f32_bf16 v197, v166, v166, v197
    v_dot2_f32_bf16 v196, v167, s70, v196
    v_dot2_f32_bf16 v197, v167, v167, v197
    v_dot2_f32_bf16 v196, v168, s70, v196
    v_dot2_f32_bf16 v197, v168, v168, v197
    v_dot2_f32_bf16 v196, v169, s70, v196
    v_dot2_f32_bf16 v197, v169, v169, v197
    v_dot2_f32_bf16 v196, v170, s70, v196
    v_dot2_f32_bf16 v197, v170, v170, v197
    v_dot2_f32_bf16 v196, v171, s70, v196
    v_dot2_f32_bf16 v197, v171, v171, v197
    v_dot2_f32_bf16 v196, v172, s70, v196
    v_dot2_f32_bf16 v197, v172, v172, v197
    v_dot2_f32_bf16 v196, v173, s70, v196
    v_dot2_f32_bf16 v197, v173, v173, v197
    v_dot2_f32_bf16 v196, v174, s70, v196
    v_dot2_f32_bf16 v197, v174, v174, v197
    v_dot2_f32_bf16 v196, v175, s70, v196
    v_dot2_f32_bf16 v197, v175, v175, v197
    s_nop 1
    v_add_f32_dpp v196, v196, v196 row_ror:8 row_mask:0xf bank_mask:0xf
    v_add_f32_dpp v197, v197, v197 row_ror:8 row_mask:0xf bank_mask:0xf
    s_nop 1
    v_add_f32_dpp v196, v196, v196 row_ror:4 row_mask:0xf bank_mask:0xf
    v_add_f32_dpp v197, v197, v197 row_ror:4 row_mask:0xf bank_mask:0xf
    s_nop 1
    v_add_f32_dpp v196, v196, v196 row_ror:2 row_mask:0xf bank_mask:0xf
    v_add_f32_dpp v197, v197, v197 row_ror:2 row_mask:0xf bank_mask:0xf
    s_nop 1
    v_add_f32_dpp v196, v196, v196 row_ror:1 row_mask:0xf bank_mask:0xf
    v_add_f32_dpp v197, v197, v197 row_ror:1 row_mask:0xf bank_mask:0xf
    s_mov_b32 s71, 0x3acccccd
    s_mov_b32 s72, 0x3727c5ac
    v_mul_f32 v196, s71, v196
    v_mul_f32 v197, s71, v197
    v_fma_f32 v197, -v196, v196, v197
    v_max_f32 v197, 0, v197
    v_add_f32 v198, s72, v197
    v_rsq_f32 v199, v198
    s_nop 0
    v_mul_f32 v200, v199, v199
    v_mul_f32 v200, v200, v197
    v_add_f32 v200, s72, v200
    v_rsq_f32 v200, v200
    s_nop 0
    v_mul_f32 v203, v199, v200
    v_rcp_f32 v201, v203
    v_sub_f32 v204, 0, v196
    v_and_b32 v205, 0xffff0000, v204
    v_sub_f32 v206, v204, v205
    v_cvt_pk_bf16_f32 v200, v205, v206
    v_and_b32 v205, 0xffff0000, v201
    v_sub_f32 v206, v201, v205
    v_cvt_pk_bf16_f32 v201, v205, v206
    v_mov_b32 v202, v199
    v_lshlrev_b32 v151, 4, v146
    v_add_u32 v151, 29360128, v151
    v_mov_b32 v152, 2048
    v_cmp_eq_u32 vcc, 0, v145
    v_cmp_gt_u32 s[74:75], 9, v144
    v_cmp_lt_u32 s[76:77], v146, v152
    s_nop 1
    s_and_b64 vcc, vcc, s[74:75]
    s_and_b64 vcc, vcc, s[76:77]
    s_nop 1
    v_cndmask_b32 v151, v148, v151, vcc
    buffer_store_dwordx4 v[200:203], v151, s[24:27], 0 offen sc1
    v_mov_b32 v156, 0
    v_mov_b32 v157, 0
    v_mov_b32 v158, 0
    v_mov_b32 v159, 0
    v_mov_b32 v160, 0
    v_mov_b32 v161, 0
    v_mov_b32 v162, 0
    v_mov_b32 v163, 0
    s_mov_b32 s70, 0x00003f80
    s_mov_b32 s71, 0x3f800000
    s_waitcnt vmcnt(63)
    v_dot2_f32_bf16 v156, v176, s70, v156
    v_dot2_f32_bf16 v157, v176, s71, v157
    v_dot2_f32_bf16 v158, v177, s70, v158
    v_dot2_f32_bf16 v159, v177, s71, v159
    v_dot2_f32_bf16 v160, v178, s70, v160
    v_dot2_f32_bf16 v161, v178, s71, v161
    v_dot2_f32_bf16 v162, v179, s70, v162
    v_dot2_f32_bf16 v163, v179, s71, v163
    v_dot2_f32_bf16 v156, v180, s70, v156
    v_dot2_f32_bf16 v157, v180, s71, v157
    v_dot2_f32_bf16 v158, v181, s70, v158
    v_dot2_f32_bf16 v159, v181, s71, v159
    v_dot2_f32_bf16 v160, v182, s70, v160
    v_dot2_f32_bf16 v161, v182, s71, v161
    v_dot2_f32_bf16 v162, v183, s70, v162
    v_dot2_f32_bf16 v163, v183, s71, v163
    v_dot2_f32_bf16 v156, v184, s70, v156
    v_dot2_f32_bf16 v157, v184, s71, v157
    v_dot2_f32_bf16 v158, v185, s70, v158
    v_dot2_f32_bf16 v159, v185, s71, v159
    v_dot2_f32_bf16 v160, v186, s70, v160
    v_dot2_f32_bf16 v161, v186, s71, v161
    v_dot2_f32_bf16 v162, v187, s70, v162
    v_dot2_f32_bf16 v163, v187, s71, v163
    v_dot2_f32_bf16 v156, v188, s70, v156
    v_dot2_f32_bf16 v157, v188, s71, v157
    v_dot2_f32_bf16 v158, v189, s70, v158
    v_dot2_f32_bf16 v159, v189, s71, v159
    v_dot2_f32_bf16 v160, v190, s70, v160
    v_dot2_f32_bf16 v161, v190, s71, v161
    v_dot2_f32_bf16 v162, v191, s70, v162
    v_dot2_f32_bf16 v163, v191, s71, v163
    v_dot2_f32_bf16 v156, v192, s70, v156
    v_dot2_f32_bf16 v157, v192, s71, v157
    v_dot2_f32_bf16 v158, v193, s70, v158
    v_dot2_f32_bf16 v159, v193, s71, v159
    v_dot2_f32_bf16 v160, v194, s70, v160
    v_dot2_f32_bf16 v161, v194, s71, v161
    v_dot2_f32_bf16 v162, v195, s70, v162
    v_dot2_f32_bf16 v163, v195, s71, v163
    s_lshl_b32 s67, s40, 11
    s_add_u32 s67, s67, 147456
    v_lshlrev_b32 v153, 5, v1
    v_add_u32 v153, s67, v153
    ds_write_b128 v153, v[156:159]
    ds_write_b128 v153, v[160:163] offset:16
    v_lshlrev_b32 v154, 2, v1
    v_add_u32 v154, s67, v154
    s_waitcnt lgkmcnt(0)
    ds_read_b32 v164, v154 offset:0
    ds_read_b32 v165, v154 offset:256
    ds_read_b32 v166, v154 offset:512
    ds_read_b32 v167, v154 offset:768
    ds_read_b32 v168, v154 offset:1024
    ds_read_b32 v169, v154 offset:1280
    ds_read_b32 v170, v154 offset:1536
    ds_read_b32 v171, v154 offset:1792
    s_lshl_b32 s67, s63, 6
    v_add_u32 v155, s67, v1
    v_lshlrev_b32 v155, 2, v155
    s_lshl_b32 s67, s64, 2
    s_add_u32 s67, s67, s40
    s_mul_i32 s67, s67, 14848
    s_add_u32 s67, s67, 29884416
    s_cmp_lt_u32 s82, 228
    s_cselect_b32 s67, s67, 2146435072
    v_add_u32 v155, s67, v155
    s_waitcnt lgkmcnt(0)
    v_add_f32 v164, v164, v165
    v_add_f32 v164, v164, v166
    v_add_f32 v164, v164, v167
    v_add_f32 v164, v164, v168
    v_add_f32 v164, v164, v169
    v_add_f32 v164, v164, v170
    v_add_f32 v164, v164, v171
    buffer_store_dword v164, v155, s[24:27], 0 offen sc1
    s_waitcnt vmcnt(0)
    s_barrier
    s_cmp_eq_u32 s40, 0
    s_cbranch_scc0 k1_kernel_idpf2
    s_and_b32 s67, s82, 1
    s_lshl_b32 s67, s67, 7
    v_mov_b32 v10, s67
    v_mov_b32 v11, 1
    v_cmp_eq_u32 vcc, 0, v1
    s_and_saveexec_b64 s[74:75], vcc
    s_cbranch_execz k1_kernel_tsidle
    global_atomic_add v10, v11, s[80:81] sc1
k1_kernel_tsidle:
    s_mov_b64 exec, s[74:75]
    s_branch k1_kernel_idpf2
k1_kernel_idpf:
    s_cmp_lt_u32 s2, 228
    s_cbranch_scc0 k1_kernel_idpf2
    s_barrier
k1_kernel_idpf2:
    s_load_dwordx2 s[64:65], s[0:1], 56
    s_load_dwordx2 s[66:67], s[0:1], 24
    s_lshl_b32 s68, s39, 2
    s_add_u32 s68, s68, s37
    s_sub_u32 s68, s68, 28
    s_lshl_b32 s68, s68, 3
    s_add_u32 s68, s68, s40
    s_lshl_b32 s68, s68, 6
    v_add_u32 v16, s68, v1
    s_waitcnt lgkmcnt(0)
    s_mov_b32 s72, s64
    s_mov_b32 s73, s65
    s_mov_b32 s74, 2211840
    s_mov_b32 s75, 0x20000
    s_mov_b32 s76, s66
    s_mov_b32 s77, s67
    s_mov_b32 s78, 819200
    s_mov_b32 s79, 0x20000
    s_mov_b32 s24, s10
    s_mov_b32 s25, s11
    s_mov_b32 s26, 33554432
    s_mov_b32 s27, 0x20000
    v_lshlrev_b32 v17, 7, v16
    buffer_load_dword v32, v17, s[72:75], 0 offen
    v_add_u32 v17, 1048576, v17
    buffer_load_dword v33, v17, s[72:75], 0 offen
    v_add_u32 v17, 1048576, v17
    buffer_load_dword v34, v17, s[72:75], 0 offen
    v_add_u32 v17, 1048576, v17
    v_lshlrev_b32 v17, 7, v16
    buffer_load_dword v36, v17, s[76:79], 0 offen
    s_mov_b32 s70, 52429
    s_movk_i32 s71, 4736
    v_mov_b32 v20, 2146435072
    v_add_u32 v18, 0, v16
    v_mul_lo_u32 v19, v18, s70
    v_lshrrev_b32 v19, 19, v19
    v_mul_u32_u24 v21, 10, v19
    v_sub_u32 v21, v18, v21
    v_mul_lo_u32 v19, v19, s71
    v_lshl_add_u32 v19, v21, 7, v19
    v_add_u32 v19, 3456, v19
    v_cmp_gt_u32 vcc, 20480, v18
    s_nop 1
    v_cndmask_b32 v19, v20, v19, vcc
    buffer_load_dword v40, v19, s[24:27], 0 offen
    v_add_u32 v18, 8192, v16
    v_mul_lo_u32 v19, v18, s70
    v_lshrrev_b32 v19, 19, v19
    v_mul_u32_u24 v21, 10, v19
    v_sub_u32 v21, v18, v21
    v_mul_lo_u32 v19, v19, s71
    v_lshl_add_u32 v19, v21, 7, v19
    v_add_u32 v19, 3456, v19
    v_cmp_gt_u32 vcc, 20480, v18
    s_nop 1
    v_cndmask_b32 v19, v20, v19, vcc
    buffer_load_dword v41, v19, s[24:27], 0 offen
    v_add_u32 v18, 16384, v16
    v_mul_lo_u32 v19, v18, s70
    v_lshrrev_b32 v19, 19, v19
    v_mul_u32_u24 v21, 10, v19
    v_sub_u32 v21, v18, v21
    v_mul_lo_u32 v19, v19, s71
    v_lshl_add_u32 v19, v21, 7, v19
    v_add_u32 v19, 3456, v19
    v_cmp_gt_u32 vcc, 20480, v18
    s_nop 1
    v_cndmask_b32 v19, v20, v19, vcc
    buffer_load_dword v42, v19, s[24:27], 0 offen
    s_endpgm
    .p2align 8
    .type k2_kernel,@function
k2_kernel:
    s_cmp_ge_u32 s2, 496
    s_cbranch_scc0 k2_kernel_go
    s_endpgm
k2_kernel_go:
    s_load_dwordx2 s[4:5], s[0:1], 88
    s_load_dwordx2 s[6:7], s[0:1], 56
    s_load_dwordx2 s[8:9], s[0:1], 24
    s_load_dwordx2 s[10:11], s[0:1], 0
    s_load_dwordx4 s[12:15], s[0:1], 64
    s_load_dwordx2 s[76:77], s[0:1], 16
    v_and_b32 v1, 63, v0
    v_lshrrev_b32 v2, 6, v0
    s_nop 0
    v_readfirstlane_b32 s40, v2
    s_cmp_lt_u32 s2, 256
    s_cbranch_scc1 k2_kernel_oj
    s_sub_u32 s3, s2, 256
    s_and_b32 s36, s3, 7
    s_lshr_b32 s37, s3, 3
    s_mul_i32 s38, s36, 30
    s_min_u32 s39, s36, 0
    s_add_u32 s38, s38, s39
    s_add_u32 s38, s38, s37
    s_cmp_ge_u32 s38, 120
    s_cselect_b32 s39, 120, 0
    s_cselect_b32 s41, 5, 0
    s_sub_u32 s38, s38, s39
    s_mul_i32 s42, s38, 52429
    s_lshr_b32 s42, s42, 18
    s_mul_i32 s43, s42, 5
    s_sub_u32 s43, s38, s43
    s_add_u32 s43, s43, s41
    s_cmp_lt_u32 s40, 4
    s_cbranch_scc1 k2_kernel_cons
k2_kernel_prod:
    s_setprio 3
    s_sub_u32 s50, s40, 4
    v_lshrrev_b32 v3, 3, v1
    v_and_b32 v4, 7, v1
    v_lshrrev_b32 v5, 4, v1
    v_xor_b32 v7, v4, v5
    v_lshlrev_b32 v8, 4, v7
    s_movk_i32 s48, 4736
    s_mul_i32 s54, s42, 88
    s_mul_i32 s56, s50, 24
    s_add_u32 s54, s54, s56
    v_add_u32 v6, s54, v3
    v_mov_b32 v10, 2047
    v_add_u32 v11, 0, v6
    v_min_u32 v11, v11, v10
    v_mul_lo_u32 v11, v11, s48
    v_add_u32 v16, v11, v8
    v_add_u32 v11, 8, v6
    v_min_u32 v11, v11, v10
    v_mul_lo_u32 v11, v11, s48
    v_add_u32 v17, v11, v8
    v_subrev_u32 v17, 1024, v17
    v_add_u32 v11, 16, v6
    v_min_u32 v11, v11, v10
    v_mul_lo_u32 v11, v11, s48
    v_add_u32 v18, v11, v8
    v_subrev_u32 v18, 2048, v18
    v_and_b32 v5, 1, v5
    v_lshlrev_b32 v5, 1, v5
    v_xor_b32 v7, v4, v5
    v_mul_u32_u24 v6, 1280, v3
    v_lshl_add_u32 v9, v7, 4, v6
    s_lshl_b32 s55, s43, 7
    v_add_u32 v9, s55, v9
    s_mul_i32 s57, s50, 20480
    s_and_b32 s58, s50, 1
    s_lshl_b32 s58, s58, 6
    v_xor_b32 v16, s58, v16
    v_xor_b32 v18, s58, v18
    s_xor_b32 s58, s58, 64
    v_xor_b32 v17, s58, v17
    v_add_u32 v19, s57, v9
    v_add_u32 v20, 9216, v19
    v_xor_b32 v20, 64, v20
    s_waitcnt lgkmcnt(0)
    s_mov_b32 s16, s4
    s_mov_b32 s17, s5
    s_mov_b32 s18, 9699328
    s_mov_b32 s19, 0x20000
    s_mov_b32 s20, s6
    s_mov_b32 s21, s7
    s_mov_b32 s22, 2211840
    s_mov_b32 s23, 0x20000
    s_mov_b32 s54, 0
    s_mov_b32 s55, 0
    s_mul_i32 s56, s50, 3072
    s_lshl_b32 s57, s50, 11
    s_add_u32 s57, s57, 12288
    s_mov_b32 s60, 0
    s_cmp_eq_u32 s50, 3
    s_cbranch_scc1 k2_kernel_p3
    s_add_u32 m0, s60, s56
    s_add_u32 s61, s60, s57
    buffer_load_dwordx4 v16, s[16:19], s54 offen offset:0 lds
    buffer_load_dwordx4 v17, s[16:19], s54 offen offset:1024 lds
    buffer_load_dwordx4 v18, s[16:19], s54 offen offset:2048 lds
    s_mov_b32 m0, s61
    s_add_u32 s54, s54, 128
    buffer_load_dwordx4 v19, s[20:23], s55 offen lds
    buffer_load_dwordx4 v20, s[20:23], s55 offen offset:1024 lds
    s_add_u32 s55, s55, 81920
    s_add_u32 s60, s60, 20480
    s_cmp_ge_u32 s60, 81920
    s_cselect_b32 s60, 0, s60
    s_add_u32 m0, s60, s56
    s_add_u32 s61, s60, s57
    buffer_load_dwordx4 v16, s[16:19], s54 offen offset:0 lds
    buffer_load_dwordx4 v17, s[16:19], s54 offen offset:1024 lds
    buffer_load_dwordx4 v18, s[16:19], s54 offen offset:2048 lds
    s_mov_b32 m0, s61
    s_add_u32 s54, s54, 128
    buffer_load_dwordx4 v19, s[20:23], s55 offen lds
    buffer_load_dwordx4 v20, s[20:23], s55 offen offset:1024 lds
    s_add_u32 s55, s55, 81920
    s_add_u32 s60, s60, 20480
    s_cmp_ge_u32 s60, 81920
    s_cselect_b32 s60, 0, s60
    s_waitcnt vmcnt(5)
    s_barrier
    s_add_u32 m0, s60, s56
    s_add_u32 s61, s60, s57
    buffer_load_dwordx4 v16, s[16:19], s54 offen offset:0 lds
    buffer_load_dwordx4 v17, s[16:19], s54 offen offset:1024 lds
    buffer_load_dwordx4 v18, s[16:19], s54 offen offset:2048 lds
    s_mov_b32 m0, s61
    s_add_u32 s54, s54, 128
    buffer_load_dwordx4 v19, s[20:23], s55 offen lds
    buffer_load_dwordx4 v20, s[20:23], s55 offen offset:1024 lds
    s_add_u32 s55, s55, 81920
    s_add_u32 s60, s60, 20480
    s_cmp_ge_u32 s60, 81920
    s_cselect_b32 s60, 0, s60
    s_add_u32 m0, s60, s56
    s_add_u32 s61, s60, s57
    buffer_load_dwordx4 v16, s[16:19], s54 offen offset:0 lds
    buffer_load_dwordx4 v17, s[16:19], s54 offen offset:1024 lds
    buffer_load_dwordx4 v18, s[16:19], s54 offen offset:2048 lds
    s_mov_b32 m0, s61
    s_add_u32 s54, s54, 128
    buffer_load_dwordx4 v19, s[20:23], s55 offen lds
    buffer_load_dwordx4 v20, s[20:23], s55 offen offset:1024 lds
    s_add_u32 s55, s55, 81920
    s_add_u32 s60, s60, 20480
    s_cmp_ge_u32 s60, 81920
    s_cselect_b32 s60, 0, s60
    s_mov_b32 s62, 23
k2_kernel_ploopa:
    s_waitcnt vmcnt(10)
    s_barrier
    s_add_u32 m0, s60, s56
    s_add_u32 s61, s60, s57
    buffer_load_dwordx4 v16, s[16:19], s54 offen offset:0 lds
    buffer_load_dwordx4 v17, s[16:19], s54 offen offset:1024 lds
    buffer_load_dwordx4 v18, s[16:19], s54 offen offset:2048 lds
    s_mov_b32 m0, s61
    s_add_u32 s54, s54, 128
    buffer_load_dwordx4 v19, s[20:23], s55 offen lds
    buffer_load_dwordx4 v20, s[20:23], s55 offen offset:1024 lds
    s_add_u32 s55, s55, 81920
    s_add_u32 s60, s60, 20480
    s_cmp_ge_u32 s60, 81920
    s_cselect_b32 s60, 0, s60
    s_sub_u32 s62, s62, 1
    s_cmp_lg_u32 s62, 0
    s_cbranch_scc1 k2_kernel_ploopa
    s_waitcnt vmcnt(10)
    s_barrier
    s_mov_b32 s20, s8
    s_mov_b32 s21, s9
    s_mov_b32 s22, 819200
    s_mov_b32 s55, 0
    s_add_u32 m0, s60, s56
    s_add_u32 s61, s60, s57
    buffer_load_dwordx4 v16, s[16:19], s54 offen offset:0 sc1 lds
    buffer_load_dwordx4 v17, s[16:19], s54 offen offset:1024 sc1 lds
    buffer_load_dwordx4 v18, s[16:19], s54 offen offset:2048 sc1 lds
    s_mov_b32 m0, s61
    s_add_u32 s54, s54, 128
    buffer_load_dwordx4 v19, s[20:23], s55 offen sc1 lds
    buffer_load_dwordx4 v20, s[20:23], s55 offen offset:1024 sc1 lds
    s_add_u32 s55, s55, 81920
    s_add_u32 s60, s60, 20480
    s_cmp_ge_u32 s60, 81920
    s_cselect_b32 s60, 0, s60
    s_mov_b32 s62, 9
k2_kernel_ploop2a:
    s_waitcnt vmcnt(10)
    s_barrier
    s_add_u32 m0, s60, s56
    s_add_u32 s61, s60, s57
    buffer_load_dwordx4 v16, s[16:19], s54 offen offset:0 sc1 lds
    buffer_load_dwordx4 v17, s[16:19], s54 offen offset:1024 sc1 lds
    buffer_load_dwordx4 v18, s[16:19], s54 offen offset:2048 sc1 lds
    s_mov_b32 m0, s61
    s_add_u32 s54, s54, 128
    buffer_load_dwordx4 v19, s[20:23], s55 offen sc1 lds
    buffer_load_dwordx4 v20, s[20:23], s55 offen offset:1024 sc1 lds
    s_add_u32 s55, s55, 81920
    s_add_u32 s60, s60, 20480
    s_cmp_ge_u32 s60, 81920
    s_cselect_b32 s60, 0, s60
    s_sub_u32 s62, s62, 1
    s_cmp_lg_u32 s62, 0
    s_cbranch_scc1 k2_kernel_ploop2a
    s_waitcnt vmcnt(10)
    s_barrier
    s_waitcnt vmcnt(5)
    s_barrier
    s_waitcnt vmcnt(0)
    s_barrier
    s_endpgm
k2_kernel_p3:
    s_add_u32 m0, s60, s56
    s_add_u32 s61, s60, s57
    buffer_load_dwordx4 v16, s[16:19], s54 offen offset:0 lds
    buffer_load_dwordx4 v17, s[16:19], s54 offen offset:1024 lds
    s_mov_b32 m0, s61
    s_add_u32 s54, s54, 128
    buffer_load_dwordx4 v19, s[20:23], s55 offen lds
    buffer_load_dwordx4 v20, s[20:23], s55 offen offset:1024 lds
    s_add_u32 s55, s55, 81920
    s_add_u32 s60, s60, 20480
    s_cmp_ge_u32 s60, 81920
    s_cselect_b32 s60, 0, s60
    s_add_u32 m0, s60, s56
    s_add_u32 s61, s60, s57
    buffer_load_dwordx4 v16, s[16:19], s54 offen offset:0 lds
    buffer_load_dwordx4 v17, s[16:19], s54 offen offset:1024 lds
    s_mov_b32 m0, s61
    s_add_u32 s54, s54, 128
    buffer_load_dwordx4 v19, s[20:23], s55 offen lds
    buffer_load_dwordx4 v20, s[20:23], s55 offen offset:1024 lds
    s_add_u32 s55, s55, 81920
    s_add_u32 s60, s60, 20480
    s_cmp_ge_u32 s60, 81920
    s_cselect_b32 s60, 0, s60
    s_waitcnt vmcnt(4)
    s_barrier
    s_add_u32 m0, s60, s56
    s_add_u32 s61, s60, s57
    buffer_load_dwordx4 v16, s[16:19], s54 offen offset:0 lds
    buffer_load_dwordx4 v17, s[16:19], s54 offen offset:1024 lds
    s_mov_b32 m0, s61
    s_add_u32 s54, s54, 128
    buffer_load_dwordx4 v19, s[20:23], s55 offen lds
    buffer_load_dwordx4 v20, s[20:23], s55 offen offset:1024 lds
    s_add_u32 s55, s55, 81920
    s_add_u32 s60, s60, 20480
    s_cmp_ge_u32 s60, 81920
    s_cselect_b32 s60, 0, s60
    s_add_u32 m0, s60, s56
    s_add_u32 s61, s60, s57
    buffer_load_dwordx4 v16, s[16:19], s54 offen offset:0 lds
    buffer_load_dwordx4 v17, s[16:19], s54 offen offset:1024 lds
    s_mov_b32 m0, s61
    s_add_u32 s54, s54, 128
    buffer_load_dwordx4 v19, s[20:23], s55 offen lds
    buffer_load_dwordx4 v20, s[20:23], s55 offen offset:1024 lds
    s_add_u32 s55, s55, 81920
    s_add_u32 s60, s60, 20480
    s_cmp_ge_u32 s60, 81920
    s_cselect_b32 s60, 0, s60
    s_mov_b32 s62, 23
k2_kernel_ploopb:
    s_waitcnt vmcnt(8)
    s_barrier
    s_add_u32 m0, s60, s56
    s_add_u32 s61, s60, s57
    buffer_load_dwordx4 v16, s[16:19], s54 offen offset:0 lds
    buffer_load_dwordx4 v17, s[16:19], s54 offen offset:1024 lds
    s_mov_b32 m0, s61
    s_add_u32 s54, s54, 128
    buffer_load_dwordx4 v19, s[20:23], s55 offen lds
    buffer_load_dwordx4 v20, s[20:23], s55 offen offset:1024 lds
    s_add_u32 s55, s55, 81920
    s_add_u32 s60, s60, 20480
    s_cmp_ge_u32 s60, 81920
    s_cselect_b32 s60, 0, s60
    s_sub_u32 s62, s62, 1
    s_cmp_lg_u32 s62, 0
    s_cbranch_scc1 k2_kernel_ploopb
    s_waitcnt vmcnt(8)
    s_barrier
    s_mov_b32 s20, s8
    s_mov_b32 s21, s9
    s_mov_b32 s22, 819200
    s_mov_b32 s55, 0
    s_add_u32 m0, s60, s56
    s_add_u32 s61, s60, s57
    buffer_load_dwordx4 v16, s[16:19], s54 offen offset:0 sc1 lds
    buffer_load_dwordx4 v17, s[16:19], s54 offen offset:1024 sc1 lds
    s_mov_b32 m0, s61
    s_add_u32 s54, s54, 128
    buffer_load_dwordx4 v19, s[20:23], s55 offen sc1 lds
    buffer_load_dwordx4 v20, s[20:23], s55 offen offset:1024 sc1 lds
    s_add_u32 s55, s55, 81920
    s_add_u32 s60, s60, 20480
    s_cmp_ge_u32 s60, 81920
    s_cselect_b32 s60, 0, s60
    s_mov_b32 s62, 9
k2_kernel_ploop2b:
    s_waitcnt vmcnt(8)
    s_barrier
    s_add_u32 m0, s60, s56
    s_add_u32 s61, s60, s57
    buffer_load_dwordx4 v16, s[16:19], s54 offen offset:0 sc1 lds
    buffer_load_dwordx4 v17, s[16:19], s54 offen offset:1024 sc1 lds
    s_mov_b32 m0, s61
    s_add_u32 s54, s54, 128
    buffer_load_dwordx4 v19, s[20:23], s55 offen sc1 lds
    buffer_load_dwordx4 v20, s[20:23], s55 offen offset:1024 sc1 lds
    s_add_u32 s55, s55, 81920
    s_add_u32 s60, s60, 20480
    s_cmp_ge_u32 s60, 81920
    s_cselect_b32 s60, 0, s60
    s_sub_u32 s62, s62, 1
    s_cmp_lg_u32 s62, 0
    s_cbranch_scc1 k2_kernel_ploop2b
    s_waitcnt vmcnt(8)
    s_barrier
    s_waitcnt vmcnt(4)
    s_barrier
    s_waitcnt vmcnt(0)
    s_barrier
    s_endpgm
k2_kernel_cons:
    s_lshr_b32 s44, s40, 1
    s_and_b32 s45, s40, 1
    v_and_b32 v8, 15, v1
    v_lshrrev_b32 v9, 4, v1
    v_lshrrev_b32 v10, 1, v8
    v_xor_b32 v10, v10, v9
    v_lshlrev_b32 v10, 4, v10
    s_mul_i32 s46, s44, 48
    v_add_u32 v11, s46, v8
    v_lshl_add_u32 v2, v11, 7, v10
    v_xor_b32 v3, 64, v2
    v_bfe_u32 v10, v1, 2, 2
    v_and_b32 v11, 3, v1
    v_lshrrev_b32 v12, 1, v10
    v_and_b32 v13, 1, v9
    v_lshl_add_u32 v12, v13, 1, v12
    v_lshlrev_b32 v12, 2, v12
    s_lshl_b32 s46, s45, 3
    v_add_u32 v13, s46, v11
    v_lshl_add_u32 v14, v9, 3, v10
    v_lshlrev_b32 v14, 7, v14
    v_add_u32 v14, 12288, v14
    v_xor_b32 v15, v13, v12
    v_lshl_add_u32 v4, v15, 3, v14
    v_add_u32 v13, 4, v13
    v_xor_b32 v15, v13, v12
    v_lshl_add_u32 v5, v15, 3, v14
    v_mov_b32 v16, 0
    v_mov_b32 v17, 0
    v_mov_b32 v18, 0
    v_mov_b32 v19, 0
    v_mov_b32 v20, 0
    v_mov_b32 v21, 0
    v_mov_b32 v22, 0
    v_mov_b32 v23, 0
    v_mov_b32 v24, 0
    v_mov_b32 v25, 0
    v_mov_b32 v26, 0
    v_mov_b32 v27, 0
    v_mov_b32 v28, 0
    v_mov_b32 v29, 0
    v_mov_b32 v30, 0
    v_mov_b32 v31, 0
    v_mov_b32 v32, 0
    v_mov_b32 v33, 0
    v_mov_b32 v34, 0
    v_mov_b32 v35, 0
    v_mov_b32 v36, 0
    v_mov_b32 v37, 0
    v_mov_b32 v38, 0
    v_mov_b32 v39, 0
    v_mov_b32 v120, 0
    s_mov_b32 s50, 0
    v_add_u32 v6, s50, v2
    v_add_u32 v7, s50, v3
    v_add_u32 v12, s50, v4
    v_add_u32 v13, s50, v5
    s_add_u32 s50, s50, 20480
    s_cmp_ge_u32 s50, 81920
    s_cselect_b32 s50, 0, s50
    s_barrier
    ds_read_b64_tr_b16 v[64:65], v12 offset:0
    ds_read_b64_tr_b16 v[66:67], v12 offset:512
    ds_read_b64_tr_b16 v[68:69], v13 offset:0
    ds_read_b64_tr_b16 v[70:71], v13 offset:512
    ds_read_b128 v[40:43], v6 offset:0
    ds_read_b128 v[44:47], v6 offset:2048
    ds_read_b128 v[48:51], v6 offset:4096
    ds_read_b64_tr_b16 v[72:73], v12 offset:4096
    ds_read_b64_tr_b16 v[74:75], v12 offset:4608
    ds_read_b64_tr_b16 v[76:77], v13 offset:4096
    ds_read_b64_tr_b16 v[78:79], v13 offset:4608
    ds_read_b128 v[52:55], v7 offset:0
    ds_read_b128 v[56:59], v7 offset:2048
    ds_read_b128 v[60:63], v7 offset:4096
    v_add_u32 v6, s50, v2
    v_add_u32 v7, s50, v3
    v_add_u32 v12, s50, v4
    v_add_u32 v13, s50, v5
    s_add_u32 s50, s50, 20480
    s_cmp_ge_u32 s50, 81920
    s_cselect_b32 s50, 0, s50
    s_waitcnt lgkmcnt(0)
    s_mov_b32 s51, 18
k2_kernel_cloop:
    s_barrier
    v_mfma_f32_16x16x32_bf16 v[16:19], v[64:67], v[40:43], v[16:19]
    ds_read_b64_tr_b16 v[104:105], v12 offset:0
    ds_read_b64_tr_b16 v[106:107], v12 offset:512
    v_mfma_f32_16x16x32_bf16 v[20:23], v[68:71], v[40:43], v[20:23]
    ds_read_b64_tr_b16 v[108:109], v13 offset:0
    ds_read_b64_tr_b16 v[110:111], v13 offset:512
    v_mfma_f32_16x16x32_bf16 v[24:27], v[64:67], v[44:47], v[24:27]
    ds_read_b128 v[80:83], v6 offset:0
    ds_read_b128 v[84:87], v6 offset:2048
    v_mfma_f32_16x16x32_bf16 v[28:31], v[68:71], v[44:47], v[28:31]
    ds_read_b128 v[88:91], v6 offset:4096
    ds_read_b64_tr_b16 v[112:113], v12 offset:4096
    v_mfma_f32_16x16x32_bf16 v[32:35], v[64:67], v[48:51], v[32:35]
    ds_read_b64_tr_b16 v[114:115], v12 offset:4608
    ds_read_b64_tr_b16 v[116:117], v13 offset:4096
    v_mfma_f32_16x16x32_bf16 v[36:39], v[68:71], v[48:51], v[36:39]
    ds_read_b64_tr_b16 v[118:119], v13 offset:4608
    ds_read_b128 v[92:95], v7 offset:0
    v_mfma_f32_16x16x32_bf16 v[16:19], v[72:75], v[52:55], v[16:19]
    ds_read_b128 v[96:99], v7 offset:2048
    ds_read_b128 v[100:103], v7 offset:4096
    v_mfma_f32_16x16x32_bf16 v[20:23], v[76:79], v[52:55], v[20:23]
    v_add_u32 v6, s50, v2
    v_add_u32 v7, s50, v3
    v_mfma_f32_16x16x32_bf16 v[24:27], v[72:75], v[56:59], v[24:27]
    v_add_u32 v12, s50, v4
    v_add_u32 v13, s50, v5
    v_mfma_f32_16x16x32_bf16 v[28:31], v[76:79], v[56:59], v[28:31]
    s_add_u32 s50, s50, 20480
    s_cmp_ge_u32 s50, 81920
    v_mfma_f32_16x16x32_bf16 v[32:35], v[72:75], v[60:63], v[32:35]
    s_cselect_b32 s50, 0, s50
    v_mfma_f32_16x16x32_bf16 v[36:39], v[76:79], v[60:63], v[36:39]
    s_waitcnt lgkmcnt(0)
    s_cmp_eq_u32 s40, 0
    s_cbranch_scc0 k2_kernel_nopoll
    s_cmp_eq_u32 s51, 8
    s_cbranch_scc0 k2_kernel_poll2
    s_mul_i32 s58, s42, 88
    s_add_u32 s59, s58, 87
    s_lshr_b32 s58, s58, 6
    s_lshr_b32 s59, s59, 6
    s_min_u32 s59, s59, 31
    s_add_u32 s63, s58, 1
    s_min_u32 s63, s63, s59
    s_lshl_b32 s58, s58, 8
    s_add_u32 s58, s58, 29691904
    s_lshl_b32 s59, s59, 8
    s_add_u32 s59, s59, 29691904
    s_lshl_b32 s63, s63, 8
    s_add_u32 s63, s63, 29691904
    v_mov_b32 v10, s58
    v_mov_b32 v14, s59
    v_mov_b32 v120, s63
    global_load_dword v11, v10, s[4:5] sc1
    global_load_dword v15, v14, s[4:5] sc1
    global_load_dword v121, v120, s[4:5] sc1
    s_branch k2_kernel_nopoll
k2_kernel_poll2:
    s_cmp_eq_u32 s51, 7
    s_cbranch_scc0 k2_kernel_nopoll
    s_mov_b32 s72, 1048576
k2_kernel_pc:
    s_waitcnt vmcnt(0)
    v_min3_u32 v11, v11, v15, v121
    s_nop 0
    v_readfirstlane_b32 s73, v11
    s_cmp_ge_u32 s73, 8
    s_cbranch_scc1 k2_kernel_pok
    s_sub_u32 s72, s72, 1
    s_cmp_eq_u32 s72, 0
    s_cbranch_scc1 k2_kernel_pok
    s_sleep 2
    global_load_dword v11, v10, s[4:5] sc1
    global_load_dword v15, v14, s[4:5] sc1
    global_load_dword v121, v120, s[4:5] sc1
    s_branch k2_kernel_pc
k2_kernel_pok:
k2_kernel_nopoll:
    s_barrier
    v_mfma_f32_16x16x32_bf16 v[16:19], v[104:107], v[80:83], v[16:19]
    ds_read_b64_tr_b16 v[64:65], v12 offset:0
    ds_read_b64_tr_b16 v[66:67], v12 offset:512
    v_mfma_f32_16x16x32_bf16 v[20:23], v[108:111], v[80:83], v[20:23]
    ds_read_b64_tr_b16 v[68:69], v13 offset:0
    ds_read_b64_tr_b16 v[70:71], v13 offset:512
    v_mfma_f32_16x16x32_bf16 v[24:27], v[104:107], v[84:87], v[24:27]
    ds_read_b128 v[40:43], v6 offset:0
    ds_read_b128 v[44:47], v6 offset:2048
    v_mfma_f32_16x16x32_bf16 v[28:31], v[108:111], v[84:87], v[28:31]
    ds_read_b128 v[48:51], v6 offset:4096
    ds_read_b64_tr_b16 v[72:73], v12 offset:4096
    v_mfma_f32_16x16x32_bf16 v[32:35], v[104:107], v[88:91], v[32:35]
    ds_read_b64_tr_b16 v[74:75], v12 offset:4608
    ds_read_b64_tr_b16 v[76:77], v13 offset:4096
    v_mfma_f32_16x16x32_bf16 v[36:39], v[108:111], v[88:91], v[36:39]
    ds_read_b64_tr_b16 v[78:79], v13 offset:4608
    ds_read_b128 v[52:55], v7 offset:0
    v_mfma_f32_16x16x32_bf16 v[16:19], v[112:115], v[92:95], v[16:19]
    ds_read_b128 v[56:59], v7 offset:2048
    ds_read_b128 v[60:63], v7 offset:4096
    v_mfma_f32_16x16x32_bf16 v[20:23], v[116:119], v[92:95], v[20:23]
    v_add_u32 v6, s50, v2
    v_add_u32 v7, s50, v3
    v_mfma_f32_16x16x32_bf16 v[24:27], v[112:115], v[96:99], v[24:27]
    v_add_u32 v12, s50, v4
    v_add_u32 v13, s50, v5
    v_mfma_f32_16x16x32_bf16 v[28:31], v[116:119], v[96:99], v[28:31]
    s_add_u32 s50, s50, 20480
    s_cmp_ge_u32 s50, 81920
    v_mfma_f32_16x16x32_bf16 v[32:35], v[112:115], v[100:103], v[32:35]
    s_cselect_b32 s50, 0, s50
    v_mfma_f32_16x16x32_bf16 v[36:39], v[116:119], v[100:103], v[36:39]
    s_waitcnt lgkmcnt(0)
    s_sub_u32 s51, s51, 1
    s_cmp_lg_u32 s51, 0
    s_cbranch_scc1 k2_kernel_cloop
    s_mov_b32 s24, s10
    s_mov_b32 s25, s11
    s_mov_b32 s26, 2621440
    s_mov_b32 s27, 0x20000
    s_mov_b32 s28, s14
    s_mov_b32 s29, s15
    s_mov_b32 s30, 2621440
    s_mov_b32 s31, 0x20000
    s_mov_b32 s32, s12
    s_mov_b32 s33, s13
    s_mov_b32 s34, 1280
    s_mov_b32 s35, 0x20000
    v_and_b32 v10, 7, v0
    v_lshrrev_b32 v11, 3, v0
    s_mul_i32 s46, s42, 112640
    s_lshl_b32 s47, s43, 7
    s_add_u32 s46, s46, s47
    v_lshlrev_b32 v12, 4, v10
    s_movk_i32 s48, 1280
    v_mad_u32_u24 v80, v11, s48, v12
    v_add_u32 v80, s46, v80
    buffer_load_dwordx4 v[84:87], v80, s[24:27], 0 offen
    v_add_u32 v81, 40960, v80
    buffer_load_dwordx4 v[88:91], v81, s[24:27], 0 offen
    v_add_u32 v82, 81920, v80
    buffer_load_dwordx4 v[92:95], v82, s[24:27], 0 offen
    v_add_u32 v13, s47, v12
    buffer_load_dwordx4 v[96:99], v13, s[32:35], 0 offen
    v_mov_b32 v14, 2146435072
    v_cmp_gt_u32 vcc, 24, v11
    s_nop 1
    v_cndmask_b32 v83, v14, v82, vcc
    v_mfma_f32_16x16x32_bf16 v[16:19], v[64:67], v[40:43], v[16:19]
    v_mfma_f32_16x16x32_bf16 v[20:23], v[68:71], v[40:43], v[20:23]
    v_mfma_f32_16x16x32_bf16 v[24:27], v[64:67], v[44:47], v[24:27]
    v_mfma_f32_16x16x32_bf16 v[28:31], v[68:71], v[44:47], v[28:31]
    v_mfma_f32_16x16x32_bf16 v[32:35], v[64:67], v[48:51], v[32:35]
    v_mfma_f32_16x16x32_bf16 v[36:39], v[68:71], v[48:51], v[36:39]
    v_mfma_f32_16x16x32_bf16 v[16:19], v[72:75], v[52:55], v[16:19]
    v_mfma_f32_16x16x32_bf16 v[20:23], v[76:79], v[52:55], v[20:23]
    v_mfma_f32_16x16x32_bf16 v[24:27], v[72:75], v[56:59], v[24:27]
    v_mfma_f32_16x16x32_bf16 v[28:31], v[76:79], v[56:59], v[28:31]
    v_mfma_f32_16x16x32_bf16 v[32:35], v[72:75], v[60:63], v[32:35]
    v_mfma_f32_16x16x32_bf16 v[36:39], v[76:79], v[60:63], v[36:39]
    s_barrier
    s_mul_i32 s46, s44, 48
    v_add_u32 v10, s46, v8
    v_mul_u32_u24 v10, 272, v10
    s_lshl_b32 s46, s45, 7
    v_lshl_add_u32 v11, v9, 4, s46
    v_add_u32 v10, v10, v11
    s_nop 4
    ds_write_b128 v10, v[16:19] offset:0
    ds_write_b128 v10, v[20:23] offset:64
    ds_write_b128 v10, v[24:27] offset:4352
    ds_write_b128 v10, v[28:31] offset:4416
    ds_write_b128 v10, v[32:35] offset:8704
    ds_write_b128 v10, v[36:39] offset:8768
    s_waitcnt lgkmcnt(0)
    s_barrier
    v_and_b32 v10, 7, v0
    v_lshrrev_b32 v11, 3, v0
    v_mul_u32_u24 v11, 272, v11
    v_lshl_add_u32 v11, v10, 5, v11
    ds_read_b128 v[16:19], v11 offset:0
    ds_read_b128 v[20:23], v11 offset:16
    ds_read_b128 v[24:27], v11 offset:8704
    ds_read_b128 v[28:31], v11 offset:8720
    ds_read_b128 v[32:35], v11 offset:17408
    ds_read_b128 v[36:39], v11 offset:17424
    s_waitcnt vmcnt(0)
    v_lshlrev_b32 v48, 16, v96
    v_and_b32 v49, 0xffff0000, v96
    v_lshlrev_b32 v50, 16, v97
    v_and_b32 v51, 0xffff0000, v97
    v_lshlrev_b32 v52, 16, v98
    v_and_b32 v53, 0xffff0000, v98
    v_lshlrev_b32 v54, 16, v99
    v_and_b32 v55, 0xffff0000, v99
    s_waitcnt lgkmcnt(4)
    v_lshlrev_b32 v56, 16, v84
    v_and_b32 v57, 0xffff0000, v84
    v_pk_add_f32 v[56:57], v[56:57], v[48:49]
    v_pk_add_f32 v[16:17], v[16:17], v[56:57]
    v_cvt_pk_bf16_f32 v60, v16, v17
    v_lshlrev_b32 v56, 16, v85
    v_and_b32 v57, 0xffff0000, v85
    v_pk_add_f32 v[56:57], v[56:57], v[50:51]
    v_pk_add_f32 v[18:19], v[18:19], v[56:57]
    v_cvt_pk_bf16_f32 v61, v18, v19
    v_lshlrev_b32 v56, 16, v86
    v_and_b32 v57, 0xffff0000, v86
    v_pk_add_f32 v[56:57], v[56:57], v[52:53]
    v_pk_add_f32 v[20:21], v[20:21], v[56:57]
    v_cvt_pk_bf16_f32 v62, v20, v21
    v_lshlrev_b32 v56, 16, v87
    v_and_b32 v57, 0xffff0000, v87
    v_pk_add_f32 v[56:57], v[56:57], v[54:55]
    v_pk_add_f32 v[22:23], v[22:23], v[56:57]
    v_cvt_pk_bf16_f32 v63, v22, v23
    buffer_store_dwordx4 v[60:63], v80, s[28:31], 0 offen sc1
    s_waitcnt lgkmcnt(2)
    v_lshlrev_b32 v56, 16, v88
    v_and_b32 v57, 0xffff0000, v88
    v_pk_add_f32 v[56:57], v[56:57], v[48:49]
    v_pk_add_f32 v[24:25], v[24:25], v[56:57]
    v_cvt_pk_bf16_f32 v64, v24, v25
    v_lshlrev_b32 v56, 16, v89
    v_and_b32 v57, 0xffff0000, v89
    v_pk_add_f32 v[56:57], v[56:57], v[50:51]
    v_pk_add_f32 v[26:27], v[26:27], v[56:57]
    v_cvt_pk_bf16_f32 v65, v26, v27
    v_lshlrev_b32 v56, 16, v90
    v_and_b32 v57, 0xffff0000, v90
    v_pk_add_f32 v[56:57], v[56:57], v[52:53]
    v_pk_add_f32 v[28:29], v[28:29], v[56:57]
    v_cvt_pk_bf16_f32 v66, v28, v29
    v_lshlrev_b32 v56, 16, v91
    v_and_b32 v57, 0xffff0000, v91
    v_pk_add_f32 v[56:57], v[56:57], v[54:55]
    v_pk_add_f32 v[30:31], v[30:31], v[56:57]
    v_cvt_pk_bf16_f32 v67, v30, v31
    buffer_store_dwordx4 v[64:67], v81, s[28:31], 0 offen sc1
    s_waitcnt lgkmcnt(0)
    v_lshlrev_b32 v56, 16, v92
    v_and_b32 v57, 0xffff0000, v92
    v_pk_add_f32 v[56:57], v[56:57], v[48:49]
    v_pk_add_f32 v[32:33], v[32:33], v[56:57]
    v_cvt_pk_bf16_f32 v68, v32, v33
    v_lshlrev_b32 v56, 16, v93
    v_and_b32 v57, 0xffff0000, v93
    v_pk_add_f32 v[56:57], v[56:57], v[50:51]
    v_pk_add_f32 v[34:35], v[34:35], v[56:57]
    v_cvt_pk_bf16_f32 v69, v34, v35
    v_lshlrev_b32 v56, 16, v94
    v_and_b32 v57, 0xffff0000, v94
    v_pk_add_f32 v[56:57], v[56:57], v[52:53]
    v_pk_add_f32 v[36:37], v[36:37], v[56:57]
    v_cvt_pk_bf16_f32 v70, v36, v37
    v_lshlrev_b32 v56, 16, v95
    v_and_b32 v57, 0xffff0000, v95
    v_pk_add_f32 v[56:57], v[56:57], v[54:55]
    v_pk_add_f32 v[38:39], v[38:39], v[56:57]
    v_cvt_pk_bf16_f32 v71, v38, v39
    buffer_store_dwordx4 v[68:71], v83, s[28:31], 0 offen sc1
    s_waitcnt vmcnt(0)
    s_endpgm
k2_kernel_oj:
    s_cmp_lt_u32 s40, 4
    s_cbranch_scc1 k2_kernel_oj_go
    s_cmp_lt_u32 s2, 32
    s_cbranch_scc1 k2_kernel_red
    s_endpgm
k2_kernel_oj_go:
    s_setprio 3
    s_mov_b32 s3, s2
    s_and_b32 s43, s3, 7
    s_lshr_b32 s42, s3, 3
    s_waitcnt lgkmcnt(0)
    s_mov_b32 s24, s4
    s_mov_b32 s25, s5
    s_mov_b32 s26, 33554432
    s_mov_b32 s27, 0x20000
    s_mov_b32 s28, s76
    s_mov_b32 s29, s77
    s_mov_b32 s30, 25600
    s_mov_b32 s31, 0x20000
    s_mul_i32 s45, s42, 4
    s_add_u32 s45, s45, s40
    v_lshlrev_b32 v13, 4, v1
    v_lshlrev_b32 v14, 3, v1
    v_mov_b32 v26, 0
    v_mov_b32 v27, 0
    s_lshl_b32 s54, s45, 3
    s_add_u32 s54, s54, s43
    s_mul_i32 s54, s54, 2560
    s_add_u32 s54, s54, 16777216
    s_cmp_lt_u32 s45, 128
    s_cselect_b32 s54, s54, 2146435072
    buffer_load_dwordx4 v[16:19], v13, s[24:27], s54 offen
    buffer_load_dwordx4 v[20:23], v13, s[24:27], s54 offen offset:1024
    buffer_load_dwordx2 v[24:25], v14, s[24:27], s54 offen offset:2048
    s_cmp_eq_u32 s40, 0
    s_cbranch_scc0 k2_kernel_oj_nophi
    v_mov_b32 v8, 0
    v_mov_b32 v9, 0
    v_mov_b32 v10, 0
    v_mov_b32 v11, 0
    v_add_u32 v3, 12288, v13
    ds_write_b128 v3, v[8:11]
    ds_write_b128 v3, v[8:11] offset:1024
    s_mul_i32 s51, s43, 3200
    s_mov_b32 m0, 0
    s_nop 0
    buffer_load_dwordx4 v13, s[28:31], s51 offen lds
    buffer_load_dwordx4 v13, s[28:31], s51 offen offset:1024 lds
    buffer_load_dwordx4 v13, s[28:31], s51 offen offset:2048 lds
    buffer_load_dwordx4 v13, s[28:31], s51 offen offset:3072 lds
k2_kernel_oj_nophi:
    v_and_b32 v8, 15, v1
    v_lshrrev_b32 v9, 4, v1
    v_bfe_u32 v13, v1, 2, 2
    v_and_b32 v14, 3, v1
    v_mul_u32_u24 v15, 800, v9
    v_mul_u32_u24 v13, 40, v13
    v_add_u32 v15, v15, v13
    v_add_u32 v15, 0, v15
    v_mov_b32 v13, 12288
    v_cmp_eq_u32 vcc, v14, v9
    s_nop 1
    v_cndmask_b32 v15, v13, v15, vcc
    s_waitcnt vmcnt(0) lgkmcnt(0)
    s_barrier
    s_cmp_eq_u32 s40, 0
    s_cbranch_scc0 k2_kernel_oj_nosig
    s_cmp_lt_u32 s2, 32
    s_cbranch_scc0 k2_kernel_oj_nosig
    s_lshr_b32 s57, s2, 2
    s_lshl_b32 s57, s57, 8
    s_add_u32 s57, s57, 29687808
    v_mov_b32 v4, s57
    v_mov_b32 v5, 1
    v_cmp_eq_u32 vcc, 0, v1
    s_and_saveexec_b64 s[74:75], vcc
    s_cbranch_execz k2_kernel_oj_sigred
    global_atomic_add v4, v5, s[4:5] sc1
k2_kernel_oj_sigred:
    s_mov_b64 exec, s[74:75]
k2_kernel_oj_nosig:
    ds_read_b64_tr_b16 v[104:105], v15 offset:0
    ds_read_b64_tr_b16 v[106:107], v15 offset:160
    ds_read_b64_tr_b16 v[108:109], v15 offset:320
    ds_read_b64_tr_b16 v[110:111], v15 offset:480
    ds_read_b64_tr_b16 v[112:113], v15 offset:640
    v_mov_b32 v114, 0
    v_mov_b32 v115, 0
    ds_read_b64_tr_b16 v[116:117], v15 offset:8
    ds_read_b64_tr_b16 v[118:119], v15 offset:168
    s_waitcnt lgkmcnt(5)
    v_mfma_f32_16x16x32_bf16 v[32:35], v[104:107], v[16:19], 0
    ds_read_b64_tr_b16 v[104:105], v15 offset:328
    ds_read_b64_tr_b16 v[106:107], v15 offset:488
    s_waitcnt lgkmcnt(5)
    v_mfma_f32_16x16x32_bf16 v[32:35], v[108:111], v[20:23], v[32:35]
    ds_read_b64_tr_b16 v[108:109], v15 offset:648
    v_mov_b32 v110, 0
    v_mov_b32 v111, 0
    s_waitcnt lgkmcnt(5)
    s_nop 0
    v_mfma_f32_16x16x32_bf16 v[32:35], v[112:115], v[24:27], v[32:35]
    ds_read_b64_tr_b16 v[112:113], v15 offset:16
    ds_read_b64_tr_b16 v[114:115], v15 offset:176
    s_waitcnt lgkmcnt(5)
    v_mfma_f32_16x16x32_bf16 v[36:39], v[116:119], v[16:19], 0
    ds_read_b64_tr_b16 v[116:117], v15 offset:336
    ds_read_b64_tr_b16 v[118:119], v15 offset:496
    s_waitcnt lgkmcnt(5)
    v_mfma_f32_16x16x32_bf16 v[36:39], v[104:107], v[20:23], v[36:39]
    ds_read_b64_tr_b16 v[104:105], v15 offset:656
    v_mov_b32 v106, 0
    v_mov_b32 v107, 0
    s_waitcnt lgkmcnt(5)
    s_nop 0
    v_mfma_f32_16x16x32_bf16 v[36:39], v[108:111], v[24:27], v[36:39]
    ds_read_b64_tr_b16 v[108:109], v15 offset:24
    ds_read_b64_tr_b16 v[110:111], v15 offset:184
    s_waitcnt lgkmcnt(5)
    v_mfma_f32_16x16x32_bf16 v[40:43], v[112:115], v[16:19], 0
    ds_read_b64_tr_b16 v[112:113], v15 offset:344
    ds_read_b64_tr_b16 v[114:115], v15 offset:504
    s_waitcnt lgkmcnt(5)
    v_mfma_f32_16x16x32_bf16 v[40:43], v[116:119], v[20:23], v[40:43]
    ds_read_b64_tr_b16 v[116:117], v15 offset:664
    v_mov_b32 v118, 0
    v_mov_b32 v119, 0
    s_waitcnt lgkmcnt(5)
    s_nop 0
    v_mfma_f32_16x16x32_bf16 v[40:43], v[104:107], v[24:27], v[40:43]
    ds_read_b64_tr_b16 v[104:105], v15 offset:32
    ds_read_b64_tr_b16 v[106:107], v15 offset:192
    s_waitcnt lgkmcnt(5)
    v_mfma_f32_16x16x32_bf16 v[44:47], v[108:111], v[16:19], 0
    ds_read_b64_tr_b16 v[108:109], v15 offset:352
    ds_read_b64_tr_b16 v[110:111], v15 offset:512
    s_waitcnt lgkmcnt(5)
    v_mfma_f32_16x16x32_bf16 v[44:47], v[112:115], v[20:23], v[44:47]
    ds_read_b64_tr_b16 v[112:113], v15 offset:672
    v_mov_b32 v114, 0
    v_mov_b32 v115, 0
    s_waitcnt lgkmcnt(5)
    s_nop 0
    v_mfma_f32_16x16x32_bf16 v[44:47], v[116:119], v[24:27], v[44:47]
    s_waitcnt lgkmcnt(3)
    v_mfma_f32_16x16x32_bf16 v[48:51], v[104:107], v[16:19], 0
    s_waitcnt lgkmcnt(1)
    v_mfma_f32_16x16x32_bf16 v[48:51], v[108:111], v[20:23], v[48:51]
    s_waitcnt lgkmcnt(0)
    s_nop 0
    v_mfma_f32_16x16x32_bf16 v[48:51], v[112:115], v[24:27], v[48:51]
    s_mov_b32 s57, 0x3fb8aa3b
    v_mov_b32 v100, 1.0
    s_nop 5
    v_max3_f32 v4, v32, v33, v34
    v_min3_f32 v5, v32, v33, v34
    v_max3_f32 v4, v4, v35, v36
    v_min3_f32 v5, v5, v35, v36
    v_max3_f32 v4, v4, v37, v38
    v_min3_f32 v5, v5, v37, v38
    v_max3_f32 v4, v4, v39, v40
    v_min3_f32 v5, v5, v39, v40
    v_max3_f32 v4, v4, v41, v42
    v_min3_f32 v5, v5, v41, v42
    v_max3_f32 v4, v4, v43, v44
    v_min3_f32 v5, v5, v43, v44
    v_max3_f32 v4, v4, v45, v46
    v_min3_f32 v5, v5, v45, v46
    v_max3_f32 v4, v4, v47, v48
    v_min3_f32 v5, v5, v47, v48
    v_max3_f32 v4, v4, v49, v50
    v_min3_f32 v5, v5, v49, v50
    v_max_f32 v4, v4, v51
    v_min_f32 v5, v5, v51
    v_mul_f32 v6, s57, v100
    v_mul_f32 v4, v4, v6
    v_mul_f32 v14, v5, v6
    v_pk_fma_f32 v[56:57], v[32:33], v[6:7], v[14:15] op_sel_hi:[1,0,0] neg_lo:[1,0,0] neg_hi:[1,0,0]
    v_pk_fma_f32 v[58:59], v[34:35], v[6:7], v[14:15] op_sel_hi:[1,0,0] neg_lo:[1,0,0] neg_hi:[1,0,0]
    v_pk_fma_f32 v[60:61], v[36:37], v[6:7], v[14:15] op_sel_hi:[1,0,0] neg_lo:[1,0,0] neg_hi:[1,0,0]
    v_pk_fma_f32 v[62:63], v[38:39], v[6:7], v[14:15] op_sel_hi:[1,0,0] neg_lo:[1,0,0] neg_hi:[1,0,0]
    v_pk_fma_f32 v[64:65], v[40:41], v[6:7], v[14:15] op_sel_hi:[1,0,0] neg_lo:[1,0,0] neg_hi:[1,0,0]
    v_pk_fma_f32 v[66:67], v[42:43], v[6:7], v[14:15] op_sel_hi:[1,0,0] neg_lo:[1,0,0] neg_hi:[1,0,0]
    v_pk_fma_f32 v[68:69], v[44:45], v[6:7], v[14:15] op_sel_hi:[1,0,0] neg_lo:[1,0,0] neg_hi:[1,0,0]
    v_pk_fma_f32 v[70:71], v[46:47], v[6:7], v[14:15] op_sel_hi:[1,0,0] neg_lo:[1,0,0] neg_hi:[1,0,0]
    v_pk_fma_f32 v[72:73], v[48:49], v[6:7], v[14:15] op_sel_hi:[1,0,0] neg_lo:[1,0,0] neg_hi:[1,0,0]
    v_pk_fma_f32 v[74:75], v[50:51], v[6:7], v[14:15] op_sel_hi:[1,0,0] neg_lo:[1,0,0] neg_hi:[1,0,0]
    v_pk_fma_f32 v[32:33], v[32:33], v[6:7], v[4:5] op_sel_hi:[1,0,0] neg_lo:[0,0,1] neg_hi:[0,0,1]
    v_pk_fma_f32 v[34:35], v[34:35], v[6:7], v[4:5] op_sel_hi:[1,0,0] neg_lo:[0,0,1] neg_hi:[0,0,1]
    v_pk_fma_f32 v[36:37], v[36:37], v[6:7], v[4:5] op_sel_hi:[1,0,0] neg_lo:[0,0,1] neg_hi:[0,0,1]
    v_pk_fma_f32 v[38:39], v[38:39], v[6:7], v[4:5] op_sel_hi:[1,0,0] neg_lo:[0,0,1] neg_hi:[0,0,1]
    v_pk_fma_f32 v[40:41], v[40:41], v[6:7], v[4:5] op_sel_hi:[1,0,0] neg_lo:[0,0,1] neg_hi:[0,0,1]
    v_pk_fma_f32 v[42:43], v[42:43], v[6:7], v[4:5] op_sel_hi:[1,0,0] neg_lo:[0,0,1] neg_hi:[0,0,1]
    v_pk_fma_f32 v[44:45], v[44:45], v[6:7], v[4:5] op_sel_hi:[1,0,0] neg_lo:[0,0,1] neg_hi:[0,0,1]
    v_pk_fma_f32 v[46:47], v[46:47], v[6:7], v[4:5] op_sel_hi:[1,0,0] neg_lo:[0,0,1] neg_hi:[0,0,1]
    v_pk_fma_f32 v[48:49], v[48:49], v[6:7], v[4:5] op_sel_hi:[1,0,0] neg_lo:[0,0,1] neg_hi:[0,0,1]
    v_pk_fma_f32 v[50:51], v[50:51], v[6:7], v[4:5] op_sel_hi:[1,0,0] neg_lo:[0,0,1] neg_hi:[0,0,1]
    v_exp_f32 v56, v56
    v_exp_f32 v57, v57
    v_exp_f32 v58, v58
    v_exp_f32 v59, v59
    v_exp_f32 v60, v60
    v_exp_f32 v61, v61
    v_exp_f32 v62, v62
    v_exp_f32 v63, v63
    v_exp_f32 v64, v64
    v_exp_f32 v65, v65
    v_exp_f32 v66, v66
    v_exp_f32 v67, v67
    v_exp_f32 v68, v68
    v_exp_f32 v69, v69
    v_exp_f32 v70, v70
    v_exp_f32 v71, v71
    v_exp_f32 v72, v72
    v_exp_f32 v73, v73
    v_exp_f32 v74, v74
    v_exp_f32 v75, v75
    v_exp_f32 v32, v32
    v_exp_f32 v33, v33
    v_exp_f32 v34, v34
    v_exp_f32 v35, v35
    v_exp_f32 v36, v36
    v_exp_f32 v37, v37
    v_exp_f32 v38, v38
    v_exp_f32 v39, v39
    v_exp_f32 v40, v40
    v_exp_f32 v41, v41
    v_exp_f32 v42, v42
    v_exp_f32 v43, v43
    v_exp_f32 v44, v44
    v_exp_f32 v45, v45
    v_exp_f32 v46, v46
    v_exp_f32 v47, v47
    v_exp_f32 v48, v48
    v_exp_f32 v49, v49
    v_exp_f32 v50, v50
    v_exp_f32 v51, v51
    v_pk_add_f32 v[4:5], v[56:57], v[58:59]
    v_pk_add_f32 v[6:7], v[32:33], v[34:35]
    v_pk_add_f32 v[4:5], v[4:5], v[60:61]
    v_pk_add_f32 v[6:7], v[6:7], v[36:37]
    v_pk_add_f32 v[4:5], v[4:5], v[62:63]
    v_pk_add_f32 v[6:7], v[6:7], v[38:39]
    v_pk_add_f32 v[4:5], v[4:5], v[64:65]
    v_pk_add_f32 v[6:7], v[6:7], v[40:41]
    v_pk_add_f32 v[4:5], v[4:5], v[66:67]
    v_pk_add_f32 v[6:7], v[6:7], v[42:43]
    v_pk_add_f32 v[4:5], v[4:5], v[68:69]
    v_pk_add_f32 v[6:7], v[6:7], v[44:45]
    v_pk_add_f32 v[4:5], v[4:5], v[70:71]
    v_pk_add_f32 v[6:7], v[6:7], v[46:47]
    v_pk_add_f32 v[4:5], v[4:5], v[72:73]
    v_pk_add_f32 v[6:7], v[6:7], v[48:49]
    v_pk_add_f32 v[4:5], v[4:5], v[74:75]
    v_pk_add_f32 v[6:7], v[6:7], v[50:51]
    v_add_f32 v4, v4, v5
    v_add_f32 v6, v6, v7
    v_rcp_f32 v4, v4
    v_rcp_f32 v6, v6
    s_nop 0
    v_pk_mul_f32 v[32:33], v[32:33], v[6:7] op_sel_hi:[1,0]
    v_pk_mul_f32 v[34:35], v[34:35], v[6:7] op_sel_hi:[1,0]
    v_pk_mul_f32 v[36:37], v[36:37], v[6:7] op_sel_hi:[1,0]
    v_pk_mul_f32 v[38:39], v[38:39], v[6:7] op_sel_hi:[1,0]
    v_pk_mul_f32 v[40:41], v[40:41], v[6:7] op_sel_hi:[1,0]
    v_pk_mul_f32 v[42:43], v[42:43], v[6:7] op_sel_hi:[1,0]
    v_pk_mul_f32 v[44:45], v[44:45], v[6:7] op_sel_hi:[1,0]
    v_pk_mul_f32 v[46:47], v[46:47], v[6:7] op_sel_hi:[1,0]
    v_pk_mul_f32 v[48:49], v[48:49], v[6:7] op_sel_hi:[1,0]
    v_pk_mul_f32 v[50:51], v[50:51], v[6:7] op_sel_hi:[1,0]
    v_pk_mul_f32 v[56:57], v[56:57], v[4:5] op_sel_hi:[1,0]
    v_pk_mul_f32 v[58:59], v[58:59], v[4:5] op_sel_hi:[1,0]
    v_pk_mul_f32 v[60:61], v[60:61], v[4:5] op_sel_hi:[1,0]
    v_pk_mul_f32 v[62:63], v[62:63], v[4:5] op_sel_hi:[1,0]
    v_pk_mul_f32 v[64:65], v[64:65], v[4:5] op_sel_hi:[1,0]
    v_pk_mul_f32 v[66:67], v[66:67], v[4:5] op_sel_hi:[1,0]
    v_pk_mul_f32 v[68:69], v[68:69], v[4:5] op_sel_hi:[1,0]
    v_pk_mul_f32 v[70:71], v[70:71], v[4:5] op_sel_hi:[1,0]
    v_pk_mul_f32 v[72:73], v[72:73], v[4:5] op_sel_hi:[1,0]
    v_pk_mul_f32 v[74:75], v[74:75], v[4:5] op_sel_hi:[1,0]
    v_cvt_pk_bf16_f32 v80, v32, v33
    v_cvt_pk_bf16_f32 v81, v34, v35
    v_cvt_pk_bf16_f32 v82, v36, v37
    v_cvt_pk_bf16_f32 v83, v38, v39
    v_cvt_pk_bf16_f32 v84, v40, v41
    v_cvt_pk_bf16_f32 v85, v42, v43
    v_cvt_pk_bf16_f32 v86, v44, v45
    v_cvt_pk_bf16_f32 v87, v46, v47
    v_cvt_pk_bf16_f32 v88, v48, v49
    v_cvt_pk_bf16_f32 v89, v50, v51
    v_cvt_pk_bf16_f32 v90, v56, v57
    v_cvt_pk_bf16_f32 v91, v58, v59
    v_cvt_pk_bf16_f32 v92, v60, v61
    v_cvt_pk_bf16_f32 v93, v62, v63
    v_cvt_pk_bf16_f32 v94, v64, v65
    v_cvt_pk_bf16_f32 v95, v66, v67
    v_cvt_pk_bf16_f32 v96, v68, v69
    v_cvt_pk_bf16_f32 v97, v70, v71
    v_cvt_pk_bf16_f32 v98, v72, v73
    v_cvt_pk_bf16_f32 v99, v74, v75
    s_cmp_eq_u32 s40, 0
    s_cbranch_scc0 k2_kernel_oj_kv_17
    s_lshl_b32 s58, s43, 8
    s_add_u32 s58, s58, 29687808
    v_mov_b32 v4, s58
    s_mov_b32 s72, 1048576
k2_kernel_oj_pollkv:
    global_load_dword v5, v4, s[4:5] sc1
    s_waitcnt vmcnt(0)
    v_readfirstlane_b32 s73, v5
    s_cmp_ge_u32 s73, 4
    s_cbranch_scc1 k2_kernel_oj_pokkv
    s_sub_u32 s72, s72, 1
    s_cmp_eq_u32 s72, 0
    s_cbranch_scc1 k2_kernel_oj_pokkv
    s_sleep 4
    s_branch k2_kernel_oj_pollkv
k2_kernel_oj_pokkv:
    s_mul_i32 s51, s43, 7680
    s_add_u32 s51, s51, 29622272
    v_lshlrev_b32 v13, 4, v1
    s_mov_b32 m0, 4096
    s_add_u32 s52, s51, 4096
    buffer_load_dwordx4 v13, s[24:27], s51 offen offset:0 sc1 lds
    buffer_load_dwordx4 v13, s[24:27], s51 offen offset:1024 sc1 lds
    buffer_load_dwordx4 v13, s[24:27], s51 offen offset:2048 sc1 lds
    buffer_load_dwordx4 v13, s[24:27], s51 offen offset:3072 sc1 lds
    s_mov_b32 m0, 8192
    s_nop 0
    buffer_load_dwordx4 v13, s[24:27], s52 offen offset:0 sc1 lds
    buffer_load_dwordx4 v13, s[24:27], s52 offen offset:1024 sc1 lds
    buffer_load_dwordx4 v13, s[24:27], s52 offen offset:2048 sc1 lds
    buffer_load_dwordx4 v13, s[24:27], s52 offen offset:3072 sc1 lds
    s_waitcnt vmcnt(0)
k2_kernel_oj_kv_17:
    s_barrier
    v_lshrrev_b32 v13, 2, v8
    v_and_b32 v14, 3, v8
    v_mul_u32_u24 v15, 1920, v9
    v_mul_u32_u24 v14, 80, v14
    v_add_u32 v15, v15, v14
    v_add_u32 v15, 4096, v15
    v_mov_b32 v14, 12288
    v_cmp_eq_u32 vcc, v13, v9
    s_nop 1
    v_cndmask_b32 v15, v14, v15, vcc
    ds_read_b128 v[100:103], v15 offset:0
    ds_read_b128 v[104:107], v15 offset:16
    ds_read_b128 v[108:111], v15 offset:32
    ds_read_b128 v[112:115], v15 offset:48
    ds_read_b128 v[116:119], v15 offset:64
    ds_read_b128 v[120:123], v15 offset:320
    ds_read_b128 v[124:127], v15 offset:336
    ds_read_b128 v[56:59], v15 offset:352
    ds_read_b128 v[60:63], v15 offset:368
    ds_read_b128 v[64:67], v15 offset:384
    s_waitcnt lgkmcnt(9)
    v_mfma_f32_16x16x32_bf16 v[32:35], v[100:103], v[80:83], 0
    ds_read_b128 v[68:71], v15 offset:640
    s_waitcnt lgkmcnt(9)
    v_mfma_f32_16x16x32_bf16 v[32:35], v[104:107], v[84:87], v[32:35]
    ds_read_b128 v[72:75], v15 offset:656
    s_waitcnt lgkmcnt(9)
    v_mfma_f32_16x16x32_bf16 v[32:35], v[108:111], v[88:91], v[32:35]
    ds_read_b128 v[100:103], v15 offset:672
    s_waitcnt lgkmcnt(9)
    v_mfma_f32_16x16x32_bf16 v[32:35], v[112:115], v[92:95], v[32:35]
    ds_read_b128 v[104:107], v15 offset:688
    s_waitcnt lgkmcnt(9)
    v_mfma_f32_16x16x32_bf16 v[32:35], v[116:119], v[96:99], v[32:35]
    ds_read_b128 v[108:111], v15 offset:704
    s_waitcnt lgkmcnt(9)
    v_mfma_f32_16x16x32_bf16 v[36:39], v[120:123], v[80:83], 0
    ds_read_b128 v[112:115], v15 offset:960
    s_waitcnt lgkmcnt(9)
    v_mfma_f32_16x16x32_bf16 v[36:39], v[124:127], v[84:87], v[36:39]
    ds_read_b128 v[116:119], v15 offset:976
    s_waitcnt lgkmcnt(9)
    v_mfma_f32_16x16x32_bf16 v[36:39], v[56:59], v[88:91], v[36:39]
    ds_read_b128 v[120:123], v15 offset:992
    s_waitcnt lgkmcnt(9)
    v_mfma_f32_16x16x32_bf16 v[36:39], v[60:63], v[92:95], v[36:39]
    ds_read_b128 v[124:127], v15 offset:1008
    s_waitcnt lgkmcnt(9)
    v_mfma_f32_16x16x32_bf16 v[36:39], v[64:67], v[96:99], v[36:39]
    ds_read_b128 v[56:59], v15 offset:1024
    s_waitcnt lgkmcnt(9)
    v_mfma_f32_16x16x32_bf16 v[40:43], v[68:71], v[80:83], 0
    ds_read_b128 v[60:63], v15 offset:1280
    s_waitcnt lgkmcnt(9)
    v_mfma_f32_16x16x32_bf16 v[40:43], v[72:75], v[84:87], v[40:43]
    ds_read_b128 v[64:67], v15 offset:1296
    s_waitcnt lgkmcnt(9)
    v_mfma_f32_16x16x32_bf16 v[40:43], v[100:103], v[88:91], v[40:43]
    ds_read_b128 v[68:71], v15 offset:1312
    s_waitcnt lgkmcnt(9)
    v_mfma_f32_16x16x32_bf16 v[40:43], v[104:107], v[92:95], v[40:43]
    ds_read_b128 v[72:75], v15 offset:1328
    s_waitcnt lgkmcnt(9)
    v_mfma_f32_16x16x32_bf16 v[40:43], v[108:111], v[96:99], v[40:43]
    ds_read_b128 v[100:103], v15 offset:1344
    s_waitcnt lgkmcnt(9)
    v_mfma_f32_16x16x32_bf16 v[44:47], v[112:115], v[80:83], 0
    ds_read_b128 v[104:107], v15 offset:1600
    s_waitcnt lgkmcnt(9)
    v_mfma_f32_16x16x32_bf16 v[44:47], v[116:119], v[84:87], v[44:47]
    ds_read_b128 v[108:111], v15 offset:1616
    s_waitcnt lgkmcnt(9)
    v_mfma_f32_16x16x32_bf16 v[44:47], v[120:123], v[88:91], v[44:47]
    ds_read_b128 v[112:115], v15 offset:1632
    s_waitcnt lgkmcnt(9)
    v_mfma_f32_16x16x32_bf16 v[44:47], v[124:127], v[92:95], v[44:47]
    ds_read_b128 v[116:119], v15 offset:1648
    s_waitcnt lgkmcnt(9)
    v_mfma_f32_16x16x32_bf16 v[44:47], v[56:59], v[96:99], v[44:47]
    ds_read_b128 v[120:123], v15 offset:1664
    s_waitcnt lgkmcnt(9)
    v_mfma_f32_16x16x32_bf16 v[48:51], v[60:63], v[80:83], 0
    s_waitcnt lgkmcnt(8)
    v_mfma_f32_16x16x32_bf16 v[48:51], v[64:67], v[84:87], v[48:51]
    s_waitcnt lgkmcnt(7)
    v_mfma_f32_16x16x32_bf16 v[48:51], v[68:71], v[88:91], v[48:51]
    s_waitcnt lgkmcnt(6)
    v_mfma_f32_16x16x32_bf16 v[48:51], v[72:75], v[92:95], v[48:51]
    s_waitcnt lgkmcnt(5)
    v_mfma_f32_16x16x32_bf16 v[48:51], v[100:103], v[96:99], v[48:51]
    s_waitcnt lgkmcnt(4)
    v_mfma_f32_16x16x32_bf16 v[52:55], v[104:107], v[80:83], 0
    s_waitcnt lgkmcnt(3)
    v_mfma_f32_16x16x32_bf16 v[52:55], v[108:111], v[84:87], v[52:55]
    s_waitcnt lgkmcnt(2)
    v_mfma_f32_16x16x32_bf16 v[52:55], v[112:115], v[88:91], v[52:55]
    s_waitcnt lgkmcnt(1)
    v_mfma_f32_16x16x32_bf16 v[52:55], v[116:119], v[92:95], v[52:55]
    s_waitcnt lgkmcnt(0)
    v_mfma_f32_16x16x32_bf16 v[52:55], v[120:123], v[96:99], v[52:55]
    s_mov_b32 s57, 0x358637bd
    s_mul_i32 s53, s40, 2560
    s_add_u32 s53, s53, 14336
    v_mul_u32_u24 v10, 160, v8
    v_mul_u32_u24 v11, 40, v9
    v_add3_u32 v10, v10, v11, s53
    s_mul_i32 s55, s43, 160
    s_add_u32 s55, s55, 3456
    s_movk_i32 s56, 4736
    v_mov_b32 v6, 2146435072
    v_mov_b32 v7, 160
    v_add_u32 v2, 0, v1
    v_mul_u32_u24 v3, 205, v2
    v_lshrrev_b32 v3, 11, v3
    v_mul_u32_u24 v4, 10, v3
    v_sub_u32 v4, v2, v4
    v_lshlrev_b32 v5, 4, v2
    v_add_u32 v64, s53, v5
    v_mul_lo_u32 v3, v3, s56
    v_lshl_add_u32 v3, v4, 4, v3
    v_add_u32 v3, s55, v3
    v_cmp_lt_u32 vcc, v2, v7
    s_nop 1
    v_cndmask_b32 v68, v6, v3, vcc
    v_add_u32 v2, 64, v1
    v_mul_u32_u24 v3, 205, v2
    v_lshrrev_b32 v3, 11, v3
    v_mul_u32_u24 v4, 10, v3
    v_sub_u32 v4, v2, v4
    v_lshlrev_b32 v5, 4, v2
    v_add_u32 v65, s53, v5
    v_mul_lo_u32 v3, v3, s56
    v_lshl_add_u32 v3, v4, 4, v3
    v_add_u32 v3, s55, v3
    v_cmp_lt_u32 vcc, v2, v7
    s_nop 1
    v_cndmask_b32 v69, v6, v3, vcc
    v_add_u32 v2, 128, v1
    v_mul_u32_u24 v3, 205, v2
    v_lshrrev_b32 v3, 11, v3
    v_mul_u32_u24 v4, 10, v3
    v_sub_u32 v4, v2, v4
    v_lshlrev_b32 v5, 4, v2
    v_add_u32 v66, s53, v5
    v_mul_lo_u32 v3, v3, s56
    v_lshl_add_u32 v3, v4, 4, v3
    v_add_u32 v3, s55, v3
    v_cmp_lt_u32 vcc, v2, v7
    s_nop 1
    v_cndmask_b32 v70, v6, v3, vcc
    v_add_f32 v4, s57, v52
    v_rcp_f32 v4, v4
    s_nop 0
    v_pk_mul_f32 v[32:33], v[32:33], v[4:5] op_sel_hi:[1,0]
    v_pk_mul_f32 v[34:35], v[34:35], v[4:5] op_sel_hi:[1,0]
    v_pk_mul_f32 v[36:37], v[36:37], v[4:5] op_sel_hi:[1,0]
    v_pk_mul_f32 v[38:39], v[38:39], v[4:5] op_sel_hi:[1,0]
    v_pk_mul_f32 v[40:41], v[40:41], v[4:5] op_sel_hi:[1,0]
    v_pk_mul_f32 v[42:43], v[42:43], v[4:5] op_sel_hi:[1,0]
    v_pk_mul_f32 v[44:45], v[44:45], v[4:5] op_sel_hi:[1,0]
    v_pk_mul_f32 v[46:47], v[46:47], v[4:5] op_sel_hi:[1,0]
    v_pk_mul_f32 v[48:49], v[48:49], v[4:5] op_sel_hi:[1,0]
    v_pk_mul_f32 v[50:51], v[50:51], v[4:5] op_sel_hi:[1,0]
    v_cvt_pk_bf16_f32 v16, v32, v33
    v_cvt_pk_bf16_f32 v17, v34, v35
    v_cvt_pk_bf16_f32 v18, v36, v37
    v_cvt_pk_bf16_f32 v19, v38, v39
    v_cvt_pk_bf16_f32 v20, v40, v41
    v_cvt_pk_bf16_f32 v21, v42, v43
    v_cvt_pk_bf16_f32 v22, v44, v45
    v_cvt_pk_bf16_f32 v23, v46, v47
    v_cvt_pk_bf16_f32 v24, v48, v49
    v_cvt_pk_bf16_f32 v25, v50, v51
    ds_write_b64 v10, v[16:17] offset:0
    ds_write_b64 v10, v[18:19] offset:8
    ds_write_b64 v10, v[20:21] offset:16
    ds_write_b64 v10, v[22:23] offset:24
    ds_write_b64 v10, v[24:25] offset:32
    s_waitcnt lgkmcnt(0)
    ds_read_b128 v[104:107], v64
    ds_read_b128 v[108:111], v65
    ds_read_b128 v[112:115], v66
    s_lshl_b32 s54, s45, 4
    s_mul_i32 s54, s54, 4736
    s_cmp_lt_u32 s45, 128
    s_cselect_b32 s54, s54, 2146435072
    s_waitcnt lgkmcnt(0)
    buffer_store_dwordx4 v[104:107], v68, s[24:27], s54 offen sc1
    buffer_store_dwordx4 v[108:111], v69, s[24:27], s54 offen sc1
    buffer_store_dwordx4 v[112:115], v70, s[24:27], s54 offen sc1
    s_waitcnt vmcnt(0)
    s_barrier
    s_cmp_eq_u32 s40, 0
    s_cbranch_scc1 k2_kernel_oj_sg
    s_endpgm
k2_kernel_oj_sg:
    s_lshl_b32 s58, s42, 8
    s_add_u32 s58, s58, 29691904
    v_mov_b32 v4, s58
    v_mov_b32 v5, 1
    v_cmp_eq_u32 vcc, 0, v1
    s_and_saveexec_b64 s[74:75], vcc
    s_cbranch_execz k2_kernel_oj_sigo
    global_atomic_add v4, v5, s[4:5] sc1
k2_kernel_oj_sigo:
    s_mov_b64 exec, s[74:75]
    s_endpgm
k2_kernel_red:
    s_setprio 3
    s_mul_i32 s55, s2, 3840
    s_add_u32 s55, s55, 25165824
    v_subrev_u32 v8, 256, v0
    v_lshlrev_b32 v2, 4, v8
    v_mov_b32 v3, 2146435072
    v_mov_b32 v4, 240
    v_cmp_lt_u32 vcc, v8, v4
    s_nop 1
    v_cndmask_b32 v2, v3, v2, vcc
    s_waitcnt lgkmcnt(0)
    s_mov_b32 s24, s4
    s_mov_b32 s25, s5
    s_mov_b32 s26, 33554432
    s_mov_b32 s27, 0x20000
    buffer_load_dwordx4 v[16:19], v2, s[24:27], s55 offen
    s_add_u32 s55, s55, 122880
    buffer_load_dwordx4 v[20:23], v2, s[24:27], s55 offen
    s_add_u32 s55, s55, 122880
    buffer_load_dwordx4 v[24:27], v2, s[24:27], s55 offen
    s_add_u32 s55, s55, 122880
    buffer_load_dwordx4 v[28:31], v2, s[24:27], s55 offen
    s_add_u32 s55, s55, 122880
    buffer_load_dwordx4 v[32:35], v2, s[24:27], s55 offen
    s_add_u32 s55, s55, 122880
    buffer_load_dwordx4 v[36:39], v2, s[24:27], s55 offen
    s_add_u32 s55, s55, 122880
    buffer_load_dwordx4 v[40:43], v2, s[24:27], s55 offen
    s_add_u32 s55, s55, 122880
    buffer_load_dwordx4 v[44:47], v2, s[24:27], s55 offen
    s_add_u32 s55, s55, 122880
    buffer_load_dwordx4 v[48:51], v2, s[24:27], s55 offen
    s_add_u32 s55, s55, 122880
    buffer_load_dwordx4 v[52:55], v2, s[24:27], s55 offen
    s_add_u32 s55, s55, 122880
    buffer_load_dwordx4 v[56:59], v2, s[24:27], s55 offen
    s_add_u32 s55, s55, 122880
    buffer_load_dwordx4 v[60:63], v2, s[24:27], s55 offen
    s_add_u32 s55, s55, 122880
    buffer_load_dwordx4 v[64:67], v2, s[24:27], s55 offen
    s_add_u32 s55, s55, 122880
    buffer_load_dwordx4 v[68:71], v2, s[24:27], s55 offen
    s_add_u32 s55, s55, 122880
    buffer_load_dwordx4 v[72:75], v2, s[24:27], s55 offen
    s_add_u32 s55, s55, 122880
    buffer_load_dwordx4 v[76:79], v2, s[24:27], s55 offen
    s_mul_i32 s56, s2, 1920
    s_add_u32 s56, s56, 29622272
    v_lshlrev_b32 v5, 3, v8
    v_cndmask_b32 v5, v3, v5, vcc
    s_waitcnt vmcnt(14)
    v_pk_add_f32 v[16:17], v[16:17], v[20:21]
    v_pk_add_f32 v[18:19], v[18:19], v[22:23]
    s_waitcnt vmcnt(13)
    v_pk_add_f32 v[16:17], v[16:17], v[24:25]
    v_pk_add_f32 v[18:19], v[18:19], v[26:27]
    s_waitcnt vmcnt(12)
    v_pk_add_f32 v[16:17], v[16:17], v[28:29]
    v_pk_add_f32 v[18:19], v[18:19], v[30:31]
    s_waitcnt vmcnt(11)
    v_pk_add_f32 v[16:17], v[16:17], v[32:33]
    v_pk_add_f32 v[18:19], v[18:19], v[34:35]
    s_waitcnt vmcnt(10)
    v_pk_add_f32 v[16:17], v[16:17], v[36:37]
    v_pk_add_f32 v[18:19], v[18:19], v[38:39]
    s_waitcnt vmcnt(9)
    v_pk_add_f32 v[16:17], v[16:17], v[40:41]
    v_pk_add_f32 v[18:19], v[18:19], v[42:43]
    s_waitcnt vmcnt(8)
    v_pk_add_f32 v[16:17], v[16:17], v[44:45]
    v_pk_add_f32 v[18:19], v[18:19], v[46:47]
    s_waitcnt vmcnt(7)
    v_pk_add_f32 v[16:17], v[16:17], v[48:49]
    v_pk_add_f32 v[18:19], v[18:19], v[50:51]
    s_waitcnt vmcnt(6)
    v_pk_add_f32 v[16:17], v[16:17], v[52:53]
    v_pk_add_f32 v[18:19], v[18:19], v[54:55]
    s_waitcnt vmcnt(5)
    v_pk_add_f32 v[16:17], v[16:17], v[56:57]
    v_pk_add_f32 v[18:19], v[18:19], v[58:59]
    s_waitcnt vmcnt(4)
    v_pk_add_f32 v[16:17], v[16:17], v[60:61]
    v_pk_add_f32 v[18:19], v[18:19], v[62:63]
    s_waitcnt vmcnt(3)
    v_pk_add_f32 v[16:17], v[16:17], v[64:65]
    v_pk_add_f32 v[18:19], v[18:19], v[66:67]
    s_waitcnt vmcnt(2)
    v_pk_add_f32 v[16:17], v[16:17], v[68:69]
    v_pk_add_f32 v[18:19], v[18:19], v[70:71]
    s_waitcnt vmcnt(1)
    v_pk_add_f32 v[16:17], v[16:17], v[72:73]
    v_pk_add_f32 v[18:19], v[18:19], v[74:75]
    s_waitcnt vmcnt(0)
    v_pk_add_f32 v[16:17], v[16:17], v[76:77]
    v_pk_add_f32 v[18:19], v[18:19], v[78:79]
    v_cvt_pk_bf16_f32 v6, v16, v17
    v_cvt_pk_bf16_f32 v7, v18, v19
    buffer_store_dwordx2 v[6:7], v5, s[24:27], s56 offen sc1
    s_waitcnt vmcnt(0)
    s_endpgm
code_end:
    s_nop 0
.section .rodata,"a"
.p2align 6
.amdhsa_kernel k1_kernel
  .amdhsa_next_free_vgpr 256
  .amdhsa_next_free_sgpr 102
  .amdhsa_accum_offset 256
  .amdhsa_group_segment_fixed_size 0
  .amdhsa_kernarg_size 96
  .amdhsa_user_sgpr_count 2
  .amdhsa_user_sgpr_kernarg_segment_ptr 1
  .amdhsa_system_sgpr_workgroup_id_x 1
.end_amdhsa_kernel
.p2align 6
.amdhsa_kernel k2_kernel
  .amdhsa_next_free_vgpr 128
  .amdhsa_next_free_sgpr 102
  .amdhsa_accum_offset 128
  .amdhsa_group_segment_fixed_size 0
  .amdhsa_kernarg_size 96
  .amdhsa_user_sgpr_count 2
  .amdhsa_user_sgpr_kernarg_segment_ptr 1
  .amdhsa_system_sgpr_workgroup_id_x 1
.end_amdhsa_kernel
```
